```python
import torch

def _softmax(x, axis=-1):
    return torch.softmax(x, dim=axis)
def _gelu(x):
    return torch.nn.functional.gelu(x, approximate="tanh")
def _silu(x):
    return torch.nn.functional.silu(x)
def _sigmoid(x):
    return torch.sigmoid(x)
def _layernorm(x, axis=-1, eps=1e-5):
    m = x.mean(dim=axis, keepdim=True)
    v = x.var(dim=axis, keepdim=True, unbiased=False)
    return (x - m) / torch.sqrt(v + eps)
def _scatter_add(tgt, idx, src, axis=0):
    return tgt.clone().index_add_(axis, idx, src)
def _segment_sum(src, seg, n):
    out = torch.zeros((n,) + src.shape[1:], dtype=src.dtype)
    return out.index_add_(0, seg, src)
def _pad(x, pw):
    flat = tuple(v for pair in reversed(pw) for v in pair)
    return torch.nn.functional.pad(x, flat)

kernel_name = 'gated_mix__spectral_fnet__swiglu_ffn__prompt'

def setup_inputs():

    _w = (lambda a: (lambda t: t.to(torch.bfloat16) if t.is_floating_point() else t)(torch.as_tensor(a)))
    def _A_setup():
        B, S, D = 1, 2048, 512
        ns = torch.arange(S)[:, None] * torch.arange(S)[None, :]
        nd = torch.arange(D)[:, None] * torch.arange(D)[None, :]
        Ws_re = torch.cos(-2.0 * torch.pi * ns / S).to(float)
        Ws_im = torch.sin(-2.0 * torch.pi * ns / S).to(float)
        Wd_re = torch.cos(-2.0 * torch.pi * nd / D).to(float)
        Wd_im = torch.sin(-2.0 * torch.pi * nd / D).to(float)
        return {
            "x": _w((lambda *s: torch.randn(*s, dtype=torch.bfloat16) * 0.05)(B, S, D)),
            "dft_seq_re": _w(Ws_re),
            "dft_seq_im": _w(Ws_im),
            "dft_hid_re": _w(Wd_re),
            "dft_hid_im": _w(Wd_im),
        }
    _A_in = _A_setup()

    def _B_setup():
        B, S, D, F = 1, 2048, 512, 1792
        return {
            "x": _w((lambda *s: torch.randn(*s, dtype=torch.bfloat16) * 0.05)(B, S, D)),
            "w_gate": _w((lambda *s: torch.randn(*s, dtype=torch.bfloat16) * 0.8)(D, F)),
            "w_up": _w((lambda *s: torch.randn(*s, dtype=torch.bfloat16) * 0.8)(D, F)),
            "w_down": _w((lambda *s: torch.randn(*s, dtype=torch.bfloat16) * 0.8)(F, D)),
        }
    _B_in = _B_setup()

    return {
        "A_x": _A_in["x"],
        "A_dft_seq_re": _A_in["dft_seq_re"],
        "A_dft_seq_im": _A_in["dft_seq_im"],
        "A_dft_hid_re": _A_in["dft_hid_re"],
        "A_dft_hid_im": _A_in["dft_hid_im"],
        "B_x": _B_in["x"],
        "B_w_gate": _B_in["w_gate"],
        "B_w_up": _B_in["w_up"],
        "B_w_down": _B_in["w_down"],
        "gate_w": _w((lambda *s: torch.randn(*s, dtype=torch.bfloat16) * 0.05)(512) * 16.0),
    }

def reference(A_x, A_dft_seq_re, A_dft_seq_im, A_dft_hid_re, A_dft_hid_im, B_x, B_w_gate, B_w_up, B_w_down, gate_w):
    def _A_ref(x, dft_seq_re, dft_seq_im, dft_hid_re, dft_hid_im):
        a = torch.einsum("bsd,ed->bse", x, dft_hid_re)
        b = torch.einsum("bsd,ed->bse", x, dft_hid_im)
        y = torch.einsum("ts,bse->bte", dft_seq_re, a) - torch.einsum("ts,bse->bte", dft_seq_im, b)
        return y

    def _B_ref(x, w_gate, w_up, w_down):
        g = _silu(x @ w_gate)
        u = x @ w_up
        return (g * u) @ w_down

    x = A_x
    g = _sigmoid((x * gate_w).sum(-1, keepdims=True))
    a = _A_ref(x, A_dft_seq_re, A_dft_seq_im, A_dft_hid_re, A_dft_hid_im)
    b = _B_ref(x, B_w_gate, B_w_up, B_w_down)
    return g * a + (1 - g) * b
```

```asm
; @launch grid=(256,1,1) block=(256,1,1) lds=147456
.amdgcn_target "amdgcn-amd-amdhsa--gfx950"
.text
.globl gated_mix__spectral_fnet__swiglu_ffn__prompt_kernel
.p2align 8
.type gated_mix__spectral_fnet__swiglu_ffn__prompt_kernel,@function
gated_mix__spectral_fnet__swiglu_ffn__prompt_kernel:
    s_cmp_ge_u32 s2, 256
    s_cbranch_scc1 K_END
    s_load_dwordx2 s[40:41], s[0:1], 0
    s_load_dwordx4 s[44:47], s[0:1], 24
    s_load_dwordx8 s[52:59], s[0:1], 48
    s_load_dwordx4 s[60:63], s[0:1], 80
    s_load_dwordx2 s[42:43], s[0:1], 96
    s_getpc_b64 s[36:37]
PCREF:
    v_lshlrev_b32 v2, 7, v0
    v_min_u32 v2, CODE_END-PCREF-4, v2
    v_mov_b32 v3, s37
    v_add_co_u32 v2, vcc, s36, v2
    v_addc_co_u32 v3, vcc, 0, v3, vcc
    global_load_dword v255, v[2:3], off
    v_lshrrev_b32 v1, 6, v0
    v_and_b32 v0, 63, v0
    v_readfirstlane_b32 s3, v1
    s_and_b32 s4, s2, 7
    s_lshr_b32 s5, s2, 3
    s_and_b32 s6, s4, 1
    s_lshl_b32 s6, s6, 3
    s_and_b32 s7, s5, 7
    s_add_u32 s6, s6, s7
    s_lshr_b32 s7, s4, 1
    s_lshl_b32 s7, s7, 2
    s_lshr_b32 s36, s5, 3
    s_add_u32 s7, s7, s36
    s_lshl_b32 s64, s6, 6
    s_lshr_b32 s36, s3, 1
    s_add_u32 s64, s64, s36
    s_lshl_b32 s37, s6, 5
    s_lshl_b32 s66, s36, 10
    s_add_u32 s38, s3, 1
    s_lshr_b32 s38, s38, 1
    s_cmp_ge_u32 s7, 14
    s_cselect_b64 s[68:69], -1, 0
    s_cselect_b32 s64, s37, s64
    s_cselect_b32 s66, s66, 0
    s_cselect_b32 s38, s38, s3
    s_movk_i32 s67, 0x400
    s_cselect_b32 s67, 0x200, s67
    s_movk_i32 s37, 3584
    s_cselect_b32 s37, 0x400, s37
    s_cselect_b32 s39, 0x100, 0
    s_lshl_b32 s70, s7, 8
    s_cmp_ge_u32 s7, 14
    s_cselect_b32 s70, 0, s70
    s_and_b32 s38, s38, 1
    s_cselect_b32 s65, -1, 1
    s_cselect_b32 s67, s67, 0
    v_lshrrev_b32 v8, 3, v0
    v_and_b32 v9, 3, v8
    v_and_b32 v10, 4, v8
    v_lshl_add_u32 v9, v10, 1, v9
    v_lshlrev_b32 v8, 1, v8
    v_cndmask_b32 v8, v8, v9, s[68:69]
    v_add_u32 v8, s64, v8
    v_lshrrev_b32 v10, 4, v0
    v_xor_b32 v11, v10, v0
    v_and_b32 v11, 7, v11
    v_lshlrev_b32 v11, 4, v11
    v_cmp_eq_u32 vcc, 0, v8
    v_mov_b32 v12, s67
    v_xor_b32 v13, 64, v11
    v_cndmask_b32 v9, v8, v12, vcc
    v_mul_lo_u32 v9, v9, s65
    v_add_u32 v9, s66, v9
    v_and_b32 v9, 0x7ff, v9
    v_lshl_add_u32 v2, v9, 10, v11
    s_cmp_ge_u32 s7, 14
    s_cselect_b32 s36, 4, 16
    v_add_u32 v9, s36, v8
    v_mul_lo_u32 v9, v9, s65
    v_add_u32 v9, s66, v9
    v_and_b32 v9, 0x7ff, v9
    v_lshl_add_u32 v3, v9, 10, v13
    s_cmp_ge_u32 s7, 14
    s_cselect_b32 s36, 16, 32
    v_add_u32 v9, s36, v8
    v_mul_lo_u32 v9, v9, s65
    v_add_u32 v9, s66, v9
    v_and_b32 v9, 0x7ff, v9
    v_lshl_add_u32 v4, v9, 10, v11
    s_cmp_ge_u32 s7, 14
    s_cselect_b32 s36, 20, 48
    v_add_u32 v9, s36, v8
    v_mul_lo_u32 v9, v9, s65
    v_add_u32 v9, s66, v9
    v_and_b32 v9, 0x7ff, v9
    v_lshl_add_u32 v5, v9, 10, v13
    v_lshlrev_b32 v9, 2, v10
    v_xor_b32 v9, v9, v0
    v_and_b32 v9, 15, v9
    s_lshl_b32 s36, s3, 4
    v_add_u32 v10, s36, v10
    v_mul_lo_u32 v10, v10, s37
    v_lshl_add_u32 v6, v9, 4, v10
    v_add_u32 v6, s70, v6
    v_add_u32 v7, s39, v6
    s_lshl_b32 s71, s37, 2
    s_mul_i32 s72, s37, 52
    s_lshl_b32 s73, s3, 12
    s_lshl_b32 s74, s7, 1
    s_add_u32 s74, s74, s6
    s_and_b32 s74, s74, 0
    s_mul_i32 s75, s74, s37
    s_lshl_b32 s75, s75, 6
    s_lshl_b32 s74, s74, 7
    s_lshl_b32 s37, s37, 9
    s_waitcnt lgkmcnt(0)
    s_mov_b32 s8, s40
    s_mov_b32 s9, s41
    s_mov_b32 s10, 2097152
    s_mov_b32 s11, 0x00020000
    s_cmp_eq_u32 s7, 14
    s_cselect_b32 s50, s44, s46
    s_cselect_b32 s51, s45, s47
    s_cmp_ge_u32 s7, 14
    s_cselect_b32 s48, s50, s52
    s_cselect_b32 s49, s51, s53
    s_cselect_b32 s50, s50, s54
    s_cselect_b32 s51, s51, s55
    s_mov_b32 s12, s48
    s_mov_b32 s13, s49
    s_mov_b32 s14, s37
    s_mov_b32 s15, 0x00020000
    s_mov_b32 s16, s50
    s_mov_b32 s17, s51
    s_mov_b32 s18, s37
    s_mov_b32 s19, 0x00020000
    s_add_u32 m0, s73, 0
    s_nop 0
    buffer_load_dwordx4 v2, s[8:11], s74 offen lds
    s_add_u32 m0, s73, 1024
    s_nop 0
    buffer_load_dwordx4 v3, s[8:11], s74 offen lds
    s_add_u32 m0, s73, 2048
    s_nop 0
    buffer_load_dwordx4 v4, s[8:11], s74 offen lds
    s_add_u32 m0, s73, 3072
    s_nop 0
    buffer_load_dwordx4 v5, s[8:11], s74 offen lds
    s_add_u32 s74, s74, 128
    s_and_b32 s74, s74, 0x3ff
    s_add_u32 m0, s73, 49152
    s_nop 0
    buffer_load_dwordx4 v6, s[12:15], s75 offen lds
    s_add_u32 m0, s73, 65536
    s_nop 0
    buffer_load_dwordx4 v7, s[16:19], s75 offen lds
    s_add_u32 s75, s75, s71
    s_add_u32 m0, s73, 50176
    s_nop 0
    buffer_load_dwordx4 v6, s[12:15], s75 offen lds
    s_add_u32 m0, s73, 66560
    s_nop 0
    buffer_load_dwordx4 v7, s[16:19], s75 offen lds
    s_add_u32 s75, s75, s71
    s_add_u32 m0, s73, 51200
    s_nop 0
    buffer_load_dwordx4 v6, s[12:15], s75 offen lds
    s_add_u32 m0, s73, 67584
    s_nop 0
    buffer_load_dwordx4 v7, s[16:19], s75 offen lds
    s_add_u32 s75, s75, s71
    s_add_u32 m0, s73, 52224
    s_nop 0
    buffer_load_dwordx4 v6, s[12:15], s75 offen lds
    s_add_u32 m0, s73, 68608
    s_nop 0
    buffer_load_dwordx4 v7, s[16:19], s75 offen lds
    s_add_u32 s75, s75, s72
    s_cmp_ge_u32 s75, s37
    s_cselect_b32 s75, 0, s75
    s_mov_b32 s20, s42
    s_mov_b32 s21, s43
    s_mov_b32 s22, 10268672
    s_mov_b32 s23, 0x00020000
    s_mov_b32 s24, s56
    s_mov_b32 s25, s57
    s_mov_b32 s26, 1835008
    s_mov_b32 s27, 0x00020000
    s_mov_b32 s32, s58
    s_mov_b32 s33, s59
    s_mov_b32 s34, 1024
    s_mov_b32 s35, 0x00020000
    s_mov_b32 s28, s62
    s_mov_b32 s29, s63
    s_mov_b32 s30, 256
    s_mov_b32 s31, 0x00020000
    s_lshl_b32 s36, s3, 6
    v_add_u32 v253, s36, v0
    v_lshlrev_b32 v252, 2, v253
    s_lshl_b32 s36, s2, 13
    s_add_u32 s38, s36, 4096
    buffer_load_dword v208, v252, s[24:27], s36 offen offset:0
    buffer_load_dword v209, v252, s[24:27], s36 offen offset:1024
    buffer_load_dword v210, v252, s[24:27], s36 offen offset:2048
    buffer_load_dword v211, v252, s[24:27], s36 offen offset:3072
    buffer_load_dword v212, v252, s[24:27], s38 offen offset:0
    buffer_load_dword v213, v252, s[24:27], s38 offen offset:1024
    buffer_load_dword v214, v252, s[24:27], s38 offen offset:2048
    buffer_load_dword v215, v252, s[24:27], s38 offen offset:3072
    s_cmp_lt_u32 s4, 4
    s_cbranch_scc0 SL_DONE
    s_lshl_b32 s36, s5, 2
    s_add_u32 s36, s36, s4
    s_lshl_b32 s36, s36, 2
    s_add_u32 s76, s36, s3
    s_cmp_eq_u32 s76, 0
    s_cselect_b32 s36, 0x200, s76
    s_sub_u32 s36, 0, s36
    v_lshrrev_b32 v250, 4, v0
    v_add_u32 v251, 1, v250
    v_and_b32 v251, 2, v251
    v_cmp_ne_u32 vcc, 0, v251
    v_mov_b32 v251, s76
    v_mov_b32 v249, s36
    v_cndmask_b32 v251, v251, v249, vcc
    v_lshrrev_b32 v250, 1, v250
    v_lshl_add_u32 v251, v250, 10, v251
    v_and_b32 v251, 0x7ff, v251
    v_and_b32 v250, 15, v0
    v_lshlrev_b32 v250, 4, v250
    v_lshl_add_u32 v249, v251, 10, v250
    buffer_load_dwordx4 v[216:219], v249, s[8:11], 0 offen offset:0
    buffer_load_dwordx4 v[220:223], v249, s[8:11], 0 offen offset:256
    buffer_load_dwordx4 v[224:227], v249, s[8:11], 0 offen offset:512
    buffer_load_dwordx4 v[228:231], v249, s[8:11], 0 offen offset:768
    buffer_load_dwordx4 v[232:235], v250, s[32:35], 0 offen offset:0
    buffer_load_dwordx4 v[236:239], v250, s[32:35], 0 offen offset:256
    buffer_load_dwordx4 v[240:243], v250, s[32:35], 0 offen offset:512
    buffer_load_dwordx4 v[244:247], v250, s[32:35], 0 offen offset:768
SL_DONE:
    s_add_u32 m0, s73, 16384
    s_nop 0
    buffer_load_dwordx4 v2, s[8:11], s74 offen lds
    s_add_u32 m0, s73, 17408
    s_nop 0
    buffer_load_dwordx4 v3, s[8:11], s74 offen lds
    s_add_u32 m0, s73, 18432
    s_nop 0
    buffer_load_dwordx4 v4, s[8:11], s74 offen lds
    s_add_u32 m0, s73, 19456
    s_nop 0
    buffer_load_dwordx4 v5, s[8:11], s74 offen lds
    s_add_u32 s74, s74, 128
    s_and_b32 s74, s74, 0x3ff
    s_add_u32 m0, s73, 81920
    s_nop 0
    buffer_load_dwordx4 v6, s[12:15], s75 offen lds
    s_add_u32 m0, s73, 98304
    s_nop 0
    buffer_load_dwordx4 v7, s[16:19], s75 offen lds
    s_add_u32 s75, s75, s71
    s_add_u32 m0, s73, 82944
    s_nop 0
    buffer_load_dwordx4 v6, s[12:15], s75 offen lds
    s_add_u32 m0, s73, 99328
    s_nop 0
    buffer_load_dwordx4 v7, s[16:19], s75 offen lds
    s_add_u32 s75, s75, s71
    s_add_u32 m0, s73, 83968
    s_nop 0
    buffer_load_dwordx4 v6, s[12:15], s75 offen lds
    s_add_u32 m0, s73, 100352
    s_nop 0
    buffer_load_dwordx4 v7, s[16:19], s75 offen lds
    s_add_u32 s75, s75, s71
    s_add_u32 m0, s73, 84992
    s_nop 0
    buffer_load_dwordx4 v6, s[12:15], s75 offen lds
    s_add_u32 m0, s73, 101376
    s_nop 0
    buffer_load_dwordx4 v7, s[16:19], s75 offen lds
    s_add_u32 s75, s75, s72
    s_cmp_ge_u32 s75, s37
    s_cselect_b32 s75, 0, s75
    v_lshlrev_b32 v1, 4, v0
    s_lshl_b32 s77, s6, 6
    s_add_u32 s77, s77, s7
    s_add_u32 s77, s77, 32
    s_lshl_b32 s36, s6, 1
    s_add_u32 s36, s36, s7
    s_sub_u32 s36, s36, 14
    s_cmp_ge_u32 s7, 14
    s_cselect_b32 s77, s36, s77
    s_lshl_b32 s77, s77, 2
    s_add_u32 s77, s77, 10264576
    v_and_b32 v14, 31, v0
    v_lshrrev_b32 v15, 5, v0
    v_bfe_u32 v9, v0, 1, 3
    v_xor_b32 v9, v15, v9
    v_lshlrev_b32 v9, 4, v9
    v_lshl_add_u32 v8, v14, 7, v9
    v_xor_b32 v9, 32, v8
    v_xor_b32 v10, 64, v8
    v_xor_b32 v11, 96, v8
    v_bfe_u32 v14, v0, 2, 2
    v_lshl_add_u32 v15, v15, 3, v14
    v_lshlrev_b32 v12, 8, v15
    v_xor_b32 v14, s3, v14
    v_lshl_add_u32 v12, v14, 6, v12
    v_bfe_u32 v14, v0, 4, 1
    v_lshl_add_u32 v12, v14, 5, v12
    v_and_b32 v14, 3, v0
    v_bfrev_b32 v15, v14
    v_lshrrev_b32 v15, 30, v15
    v_cndmask_b32 v14, v15, v14, s[68:69]
    v_lshl_add_u32 v12, v14, 3, v12
    v_add_u32 v12, 49152, v12
    v_add_u32 v13, 0x10000, v12
    s_lshr_b32 s78, s4, 1
    s_lshl_b32 s78, s78, 3
    s_and_b32 s36, s5, 3
    s_lshl_b32 s36, s36, 1
    s_add_u32 s78, s78, s36
    s_and_b32 s36, s4, 1
    s_add_u32 s78, s78, s36
    s_lshr_b32 s79, s5, 2
    s_and_b32 s38, s78, 6
    s_add_u32 s38, s38, s79
    s_and_b32 s38, s38, 0
    s_lshl_b32 s38, s38, 2
    s_mul_i32 s36, s3, 28
    s_add_u32 s36, s36, s38
    s_cmp_ge_u32 s36, 112
    s_cselect_b32 s36, 0, s36
    s_lshl_b32 s36, s36, 11
    s_mul_i32 s44, s78, 229376
    s_add_u32 s80, s44, s36
    s_add_u32 s45, s44, 229376
    s_mul_i32 s46, s79, 229376
    s_add_u32 s46, s46, 7340032
    s_add_u32 s81, s46, s36
    s_add_u32 s47, s46, 229376
    s_waitcnt vmcnt(12)
    s_and_b32 s68, s68, 0xfffe
    s_or_b32 s68, s68, 1
    s_mov_b32 s69, 0
    v_lshlrev_b32 v31, 8, v0
    v_mov_b32 v248, 0
    s_mov_b64 exec, s[68:69]
    buffer_store_dword v248, v31, s[20:23], s77 offen sc1
    s_mov_b64 exec, -1
    s_cmp_ge_u32 s2, 224
    s_cbranch_scc1 SJ_GATE
    s_mov_b32 s36, 0x05040100
    s_mov_b32 s38, 0x07060302
    v_perm_b32 v16, v209, v208, s36
    v_perm_b32 v20, v209, v208, s38
    v_perm_b32 v17, v211, v210, s36
    v_perm_b32 v21, v211, v210, s38
    v_perm_b32 v18, v213, v212, s36
    v_perm_b32 v22, v213, v212, s38
    v_perm_b32 v19, v215, v214, s36
    v_perm_b32 v23, v215, v214, s38
    s_lshr_b32 s36, s2, 1
    s_lshl_b32 s36, s36, 11
    s_and_b32 s38, s2, 1
    s_lshl_b32 s38, s38, 9
    s_add_u32 s36, s36, s38
    s_add_u32 s36, s36, 7340032
    s_mov_b32 s38, 229376
    v_lshl_add_u32 v24, v253, 1, 0
    v_sub_u32 v25, 0x200, v24
    v_cmp_gt_u32 vcc, 0x100, v24
    v_and_b32 v25, 0xff, v25
    s_nop 0
    v_cndmask_b32 v25, v25, v24, vcc
    v_lshrrev_b32 v26, 5, v25
    v_mul_lo_u32 v26, v26, s38
    v_lshrrev_b32 v24, 8, v24
    v_lshl_add_u32 v26, v24, 10, v26
    v_and_b32 v25, 31, v25
    v_lshl_add_u32 v27, v25, 4, v26
    buffer_store_dwordx4 v[16:19], v27, s[20:23], s36 offen sc1
    v_lshl_add_u32 v24, v253, 1, 1
    v_sub_u32 v25, 0x200, v24
    v_cmp_gt_u32 vcc, 0x100, v24
    v_and_b32 v25, 0xff, v25
    s_nop 0
    v_cndmask_b32 v25, v25, v24, vcc
    v_lshrrev_b32 v26, 5, v25
    v_mul_lo_u32 v26, v26, s38
    v_lshrrev_b32 v24, 8, v24
    v_lshl_add_u32 v26, v24, 10, v26
    v_and_b32 v25, 31, v25
    v_lshl_add_u32 v28, v25, 4, v26
    buffer_store_dwordx4 v[20:23], v28, s[20:23], s36 offen sc1
SJ_GATE:
    s_cmp_lt_u32 s4, 4
    s_cbranch_scc0 SJ_DONE
    v_mov_b32 v208, 0
    v_mov_b32 v209, 0
    v_lshlrev_b32 v210, 16, v216
    v_lshlrev_b32 v211, 16, v232
    v_and_b32 v216, 0xffff0000, v216
    v_and_b32 v232, 0xffff0000, v232
    v_fmac_f32 v208, v210, v211
    v_add_f32 v209, v209, v210
    v_fmac_f32 v208, v216, v232
    v_sub_f32 v209, v209, v216
    v_lshlrev_b32 v210, 16, v217
    v_lshlrev_b32 v211, 16, v233
    v_and_b32 v217, 0xffff0000, v217
    v_and_b32 v233, 0xffff0000, v233
    v_fmac_f32 v208, v210, v211
    v_add_f32 v209, v209, v210
    v_fmac_f32 v208, v217, v233
    v_sub_f32 v209, v209, v217
    v_lshlrev_b32 v210, 16, v218
    v_lshlrev_b32 v211, 16, v234
    v_and_b32 v218, 0xffff0000, v218
    v_and_b32 v234, 0xffff0000, v234
    v_fmac_f32 v208, v210, v211
    v_add_f32 v209, v209, v210
    v_fmac_f32 v208, v218, v234
    v_sub_f32 v209, v209, v218
    v_lshlrev_b32 v210, 16, v219
    v_lshlrev_b32 v211, 16, v235
    v_and_b32 v219, 0xffff0000, v219
    v_and_b32 v235, 0xffff0000, v235
    v_fmac_f32 v208, v210, v211
    v_add_f32 v209, v209, v210
    v_fmac_f32 v208, v219, v235
    v_sub_f32 v209, v209, v219
    v_lshlrev_b32 v210, 16, v220
    v_lshlrev_b32 v211, 16, v236
    v_and_b32 v220, 0xffff0000, v220
    v_and_b32 v236, 0xffff0000, v236
    v_fmac_f32 v208, v210, v211
    v_add_f32 v209, v209, v210
    v_fmac_f32 v208, v220, v236
    v_sub_f32 v209, v209, v220
    v_lshlrev_b32 v210, 16, v221
    v_lshlrev_b32 v211, 16, v237
    v_and_b32 v221, 0xffff0000, v221
    v_and_b32 v237, 0xffff0000, v237
    v_fmac_f32 v208, v210, v211
    v_add_f32 v209, v209, v210
    v_fmac_f32 v208, v221, v237
    v_sub_f32 v209, v209, v221
    v_lshlrev_b32 v210, 16, v222
    v_lshlrev_b32 v211, 16, v238
    v_and_b32 v222, 0xffff0000, v222
    v_and_b32 v238, 0xffff0000, v238
    v_fmac_f32 v208, v210, v211
    v_add_f32 v209, v209, v210
    v_fmac_f32 v208, v222, v238
    v_sub_f32 v209, v209, v222
    v_lshlrev_b32 v210, 16, v223
    v_lshlrev_b32 v211, 16, v239
    v_and_b32 v223, 0xffff0000, v223
    v_and_b32 v239, 0xffff0000, v239
    v_fmac_f32 v208, v210, v211
    v_add_f32 v209, v209, v210
    v_fmac_f32 v208, v223, v239
    v_sub_f32 v209, v209, v223
    v_lshlrev_b32 v210, 16, v224
    v_lshlrev_b32 v211, 16, v240
    v_and_b32 v224, 0xffff0000, v224
    v_and_b32 v240, 0xffff0000, v240
    v_fmac_f32 v208, v210, v211
    v_add_f32 v209, v209, v210
    v_fmac_f32 v208, v224, v240
    v_sub_f32 v209, v209, v224
    v_lshlrev_b32 v210, 16, v225
    v_lshlrev_b32 v211, 16, v241
    v_and_b32 v225, 0xffff0000, v225
    v_and_b32 v241, 0xffff0000, v241
    v_fmac_f32 v208, v210, v211
    v_add_f32 v209, v209, v210
    v_fmac_f32 v208, v225, v241
    v_sub_f32 v209, v209, v225
    v_lshlrev_b32 v210, 16, v226
    v_lshlrev_b32 v211, 16, v242
    v_and_b32 v226, 0xffff0000, v226
    v_and_b32 v242, 0xffff0000, v242
    v_fmac_f32 v208, v210, v211
    v_add_f32 v209, v209, v210
    v_fmac_f32 v208, v226, v242
    v_sub_f32 v209, v209, v226
    v_lshlrev_b32 v210, 16, v227
    v_lshlrev_b32 v211, 16, v243
    v_and_b32 v227, 0xffff0000, v227
    v_and_b32 v243, 0xffff0000, v243
    v_fmac_f32 v208, v210, v211
    v_add_f32 v209, v209, v210
    v_fmac_f32 v208, v227, v243
    v_sub_f32 v209, v209, v227
    v_lshlrev_b32 v210, 16, v228
    v_lshlrev_b32 v211, 16, v244
    v_and_b32 v228, 0xffff0000, v228
    v_and_b32 v244, 0xffff0000, v244
    v_fmac_f32 v208, v210, v211
    v_add_f32 v209, v209, v210
    v_fmac_f32 v208, v228, v244
    v_sub_f32 v209, v209, v228
    v_lshlrev_b32 v210, 16, v229
    v_lshlrev_b32 v211, 16, v245
    v_and_b32 v229, 0xffff0000, v229
    v_and_b32 v245, 0xffff0000, v245
    v_fmac_f32 v208, v210, v211
    v_add_f32 v209, v209, v210
    v_fmac_f32 v208, v229, v245
    v_sub_f32 v209, v209, v229
    v_lshlrev_b32 v210, 16, v230
    v_lshlrev_b32 v211, 16, v246
    v_and_b32 v230, 0xffff0000, v230
    v_and_b32 v246, 0xffff0000, v246
    v_fmac_f32 v208, v210, v211
    v_add_f32 v209, v209, v210
    v_fmac_f32 v208, v230, v246
    v_sub_f32 v209, v209, v230
    v_lshlrev_b32 v210, 16, v231
    v_lshlrev_b32 v211, 16, v247
    v_and_b32 v231, 0xffff0000, v231
    v_and_b32 v247, 0xffff0000, v247
    v_fmac_f32 v208, v210, v211
    v_add_f32 v209, v209, v210
    v_fmac_f32 v208, v231, v247
    v_sub_f32 v209, v209, v231
    s_nop 1
    v_add_f32_dpp v208, v208, v208 row_ror:8 row_mask:0xf bank_mask:0xf
    v_add_f32_dpp v209, v209, v209 row_ror:8 row_mask:0xf bank_mask:0xf
    s_nop 1
    v_add_f32_dpp v208, v208, v208 row_ror:4 row_mask:0xf bank_mask:0xf
    v_add_f32_dpp v209, v209, v209 row_ror:4 row_mask:0xf bank_mask:0xf
    s_nop 1
    v_add_f32_dpp v208, v208, v208 row_ror:2 row_mask:0xf bank_mask:0xf
    v_add_f32_dpp v209, v209, v209 row_ror:2 row_mask:0xf bank_mask:0xf
    s_nop 1
    v_add_f32_dpp v208, v208, v208 row_ror:1 row_mask:0xf bank_mask:0xf
    v_add_f32_dpp v209, v209, v209 row_ror:1 row_mask:0xf bank_mask:0xf
    v_mul_f32 v208, 0xbfb8aa3b, v208
    v_exp_f32 v208, v208
    v_sub_u32 v210, 0x800, v251
    v_add_f32 v208, 1.0, v208
    v_rcp_f32 v208, v208
    v_cmp_gt_u32 vcc, 0x400, v251
    v_and_b32 v210, 0x3ff, v210
    s_nop 0
    v_cndmask_b32 v210, v210, v251, vcc
    v_lshrrev_b32 v211, 6, v210
    v_lshlrev_b32 v211, 7, v211
    v_and_b32 v212, 1, v210
    v_lshl_add_u32 v211, v212, 6, v211
    v_bfe_u32 v212, v210, 1, 5
    v_add_u32 v211, v211, v212
    v_lshrrev_b32 v212, 10, v251
    v_lshl_add_u32 v211, v212, 5, v211
    v_lshlrev_b32 v211, 2, v211
    s_mov_b32 s36, 10256384
    s_mov_b32 exec_lo, 0x10001
    s_mov_b32 exec_hi, 0x10001
    buffer_store_dword v208, v211, s[20:23], s36 offen sc1
    s_mov_b64 exec, -1
    v_readlane_b32 s64, v209, 0
    v_readlane_b32 s65, v209, 16
    v_readlane_b32 s66, v209, 32
    v_readlane_b32 s67, v209, 48
    s_nop 3
    v_mov_b32 v210, s66
    v_add_f32 v210, s65, v210
    s_cmp_eq_u32 s76, 0
    s_cselect_b32 s65, 0, s65
    s_cselect_b32 s66, 0, s66
    v_mov_b32 v211, s64
    v_add_f32 v211, s65, v211
    v_mov_b32 v212, s67
    v_add_f32 v212, s66, v212
    v_add_f32 v213, v211, v212
    v_sub_f32 v214, v211, v212
    v_cvt_pk_bf16_f32 v213, v213, v214
    s_lshr_b32 s36, s76, 4
    s_lshl_b32 s36, s36, 11
    s_and_b32 s38, s76, 8
    s_lshl_b32 s38, s38, 6
    s_add_u32 s36, s36, s38
    s_and_b32 s38, s76, 7
    s_lshl_b32 s38, s38, 1
    s_add_u32 s36, s36, s38
    s_add_u32 s36, s36, 9176064
    s_add_u32 s38, s36, 540672
    s_mov_b64 exec, 1
    buffer_store_short v213, v248, s[20:23], s36 offen sc1
    buffer_store_short_d16_hi v213, v248, s[20:23], s38 offen sc1
    s_mov_b64 exec, -1
    s_cmp_eq_u32 s76, 0
    s_cbranch_scc0 SJ_DONE
    v_cvt_pk_bf16_f32 v216, v210, 0
    v_cmp_eq_u32 vcc, 0, v0
    v_mov_b32 v217, 0
    v_mov_b32 v218, 0
    v_mov_b32 v219, 0
    v_cndmask_b32 v216, 0, v216, vcc
    s_mov_b32 s36, 9241600
    s_mov_b32 s38, 9782272
    s_mov_b32 exec_lo, 1
    s_mov_b32 exec_hi, 1
    buffer_store_dwordx4 v[216:219], v1, s[20:23], s36 offen sc1
    buffer_store_dwordx4 v[216:219], v1, s[20:23], s38 offen sc1
    s_mov_b64 exec, -1
SJ_DONE:
    v_and_b32 v14, 3, v0
    v_lshlrev_b32 v14, 6, v14
    v_and_b32 v16, 31, v0
    v_lshlrev_b32 v16, 2, v16
    v_lshrrev_b32 v17, 5, v0
    v_lshlrev_b32 v17, 4, v17
    s_lshl_b32 s82, s6, 9
    s_add_u32 s82, s82, 10256384
    s_lshl_b32 s83, s78, 8
    s_add_u32 s83, s83, 10256384
    s_lshr_b32 s36, s78, 1
    s_lshl_b32 s36, s36, 6
    s_and_b32 s38, s78, 1
    s_add_u32 s70, s36, s38
    v_and_b32 v208, 31, v0
    v_lshl_add_u32 v208, v208, 1, s70
    v_cmp_eq_u32 s[64:65], 0, v208
    v_lshrrev_b32 v209, 5, v0
    s_lshl_b32 s36, s3, 7
    v_lshl_add_u32 v209, v209, 3, s36
    v_mul_lo_u32 v209, v209, v208
    s_cmp_ge_u32 s7, 14
    s_cbranch_scc1 P1_DFT
    s_barrier
    ds_read_b64_tr_b16 v[176:177], v12 offset:0
    ds_read_b64_tr_b16 v[178:179], v12 offset:1024
    ds_read_b64_tr_b16 v[180:181], v12 offset:16384
    ds_read_b64_tr_b16 v[182:183], v12 offset:17408
    ds_read_b128 v[160:163], v8 offset:0
    ds_read_b128 v[164:167], v8 offset:4096
    ds_read_b128 v[168:171], v8 offset:8192
    ds_read_b128 v[172:175], v8 offset:12288
    s_waitcnt lgkmcnt(0)
    v_mfma_f32_32x32x16_bf16 v[32:47], v[176:179], v[160:163], 0
    ds_read_b64_tr_b16 v[200:201], v12 offset:4096
    v_cvt_f32_u32 v209, v209
    v_cvt_f32_u32 v208, v208
    v_mfma_f32_32x32x16_bf16 v[48:63], v[180:183], v[160:163], 0
    ds_read_b64_tr_b16 v[202:203], v12 offset:5120
    v_mul_f32 v209, 0x3a000000, v209
    v_mul_f32 v208, 0x3a000000, v208
    s_add_u32 m0, s73, 32768
    s_nop 0
    buffer_load_dwordx4 v2, s[8:11], s74 offen lds
    v_mfma_f32_32x32x16_bf16 v[64:79], v[176:179], v[164:167], 0
    ds_read_b64_tr_b16 v[204:205], v12 offset:20480
    v_mul_f32 v210, 0x41100000, v208
    v_mov_b32 v211, 0xbf803f80
    v_mfma_f32_32x32x16_bf16 v[80:95], v[180:183], v[164:167], 0
    ds_read_b64_tr_b16 v[206:207], v12 offset:21504
    v_fract_f32 v209, v209
    v_add_f32 v212, v209, v208
    s_add_u32 m0, s73, 33792
    s_nop 0
    buffer_load_dwordx4 v3, s[8:11], s74 offen lds
    v_mfma_f32_32x32x16_bf16 v[96:111], v[176:179], v[168:171], 0
    ds_read_b128 v[184:187], v9 offset:0
    v_cos_f32 v213, v209
    v_sin_f32 v214, -v209
    v_mfma_f32_32x32x16_bf16 v[112:127], v[180:183], v[168:171], 0
    ds_read_b128 v[188:191], v9 offset:4096
    v_add_f32 v209, v212, v208
    v_cos_f32 v215, v212
    s_add_u32 m0, s73, 34816
    s_nop 0
    buffer_load_dwordx4 v4, s[8:11], s74 offen lds
    v_mfma_f32_32x32x16_bf16 v[128:143], v[176:179], v[172:175], 0
    ds_read_b128 v[192:195], v9 offset:8192
    v_sin_f32 v216, -v212
    v_cvt_pk_bf16_f32 v217, v213, v215
    v_mfma_f32_32x32x16_bf16 v[144:159], v[180:183], v[172:175], 0
    ds_read_b128 v[196:199], v9 offset:12288
    v_cvt_pk_bf16_f32 v218, v214, v216
    v_accvgpr_write_b32 a152, v217
    s_add_u32 m0, s73, 35840
    s_nop 0
    buffer_load_dwordx4 v5, s[8:11], s74 offen lds
    s_add_u32 s74, s74, 128
    s_and_b32 s74, s74, 0x3ff
    s_waitcnt lgkmcnt(0)
    v_mfma_f32_32x32x16_bf16 v[32:47], v[200:203], v[184:187], v[32:47]
    ds_read_b64_tr_b16 v[176:177], v12 offset:8192
    v_cndmask_b32 v218, v218, v211, s[64:65]
    v_accvgpr_write_b32 a156, v218
    v_mfma_f32_32x32x16_bf16 v[48:63], v[204:207], v[184:187], v[48:63]
    ds_read_b64_tr_b16 v[178:179], v12 offset:9216
    v_add_f32 v212, v209, v208
    v_cos_f32 v213, v209
    s_add_u32 m0, s73, 114688
    s_nop 0
    buffer_load_dwordx4 v6, s[12:15], s75 offen lds
    v_mfma_f32_32x32x16_bf16 v[64:79], v[200:203], v[188:191], v[64:79]
    ds_read_b64_tr_b16 v[180:181], v12 offset:24576
    v_sin_f32 v214, -v209
    v_add_f32 v209, v212, v208
    v_mfma_f32_32x32x16_bf16 v[80:95], v[204:207], v[188:191], v[80:95]
    ds_read_b64_tr_b16 v[182:183], v12 offset:25600
    v_cos_f32 v215, v212
    v_sin_f32 v216, -v212
    s_add_u32 m0, s73, 131072
    s_nop 0
    buffer_load_dwordx4 v7, s[16:19], s75 offen lds
    s_add_u32 s75, s75, s71
    v_mfma_f32_32x32x16_bf16 v[96:111], v[200:203], v[192:195], v[96:111]
    ds_read_b128 v[160:163], v10 offset:0
    v_cvt_pk_bf16_f32 v217, v213, v215
    v_cvt_pk_bf16_f32 v218, v214, v216
    v_mfma_f32_32x32x16_bf16 v[112:127], v[204:207], v[192:195], v[112:127]
    ds_read_b128 v[164:167], v10 offset:4096
    v_accvgpr_write_b32 a153, v217
    v_cndmask_b32 v218, v218, v211, s[64:65]
    s_add_u32 m0, s73, 115712
    s_nop 0
    buffer_load_dwordx4 v6, s[12:15], s75 offen lds
    v_mfma_f32_32x32x16_bf16 v[128:143], v[200:203], v[196:199], v[128:143]
    ds_read_b128 v[168:171], v10 offset:8192
    v_accvgpr_write_b32 a157, v218
    v_add_f32 v212, v209, v208
    v_mfma_f32_32x32x16_bf16 v[144:159], v[204:207], v[196:199], v[144:159]
    ds_read_b128 v[172:175], v10 offset:12288
    v_cos_f32 v213, v209
    v_sin_f32 v214, -v209
    s_add_u32 m0, s73, 132096
    s_nop 0
    buffer_load_dwordx4 v7, s[16:19], s75 offen lds
    s_add_u32 s75, s75, s71
    s_waitcnt lgkmcnt(0)
    v_mfma_f32_32x32x16_bf16 v[32:47], v[176:179], v[160:163], v[32:47]
    ds_read_b64_tr_b16 v[200:201], v12 offset:12288
    v_add_f32 v209, v212, v208
    v_cos_f32 v215, v212
    v_mfma_f32_32x32x16_bf16 v[48:63], v[180:183], v[160:163], v[48:63]
    ds_read_b64_tr_b16 v[202:203], v12 offset:13312
    v_sin_f32 v216, -v212
    v_cvt_pk_bf16_f32 v217, v213, v215
    s_add_u32 m0, s73, 116736
    s_nop 0
    buffer_load_dwordx4 v6, s[12:15], s75 offen lds
    v_mfma_f32_32x32x16_bf16 v[64:79], v[176:179], v[164:167], v[64:79]
    ds_read_b64_tr_b16 v[204:205], v12 offset:28672
    v_cvt_pk_bf16_f32 v218, v214, v216
    v_accvgpr_write_b32 a154, v217
    v_mfma_f32_32x32x16_bf16 v[80:95], v[180:183], v[164:167], v[80:95]
    ds_read_b64_tr_b16 v[206:207], v12 offset:29696
    v_cndmask_b32 v218, v218, v211, s[64:65]
    v_accvgpr_write_b32 a158, v218
    s_add_u32 m0, s73, 133120
    s_nop 0
    buffer_load_dwordx4 v7, s[16:19], s75 offen lds
    s_add_u32 s75, s75, s71
    v_mfma_f32_32x32x16_bf16 v[96:111], v[176:179], v[168:171], v[96:111]
    ds_read_b128 v[184:187], v11 offset:0
    v_add_f32 v212, v209, v208
    v_cos_f32 v213, v209
    v_mfma_f32_32x32x16_bf16 v[112:127], v[180:183], v[168:171], v[112:127]
    ds_read_b128 v[188:191], v11 offset:4096
    v_sin_f32 v214, -v209
    v_add_f32 v209, v212, v210
    s_add_u32 m0, s73, 117760
    s_nop 0
    buffer_load_dwordx4 v6, s[12:15], s75 offen lds
    v_mfma_f32_32x32x16_bf16 v[128:143], v[176:179], v[172:175], v[128:143]
    ds_read_b128 v[192:195], v11 offset:8192
    v_cos_f32 v215, v212
    v_sin_f32 v216, -v212
    v_mfma_f32_32x32x16_bf16 v[144:159], v[180:183], v[172:175], v[144:159]
    ds_read_b128 v[196:199], v11 offset:12288
    v_cvt_pk_bf16_f32 v217, v213, v215
    v_cvt_pk_bf16_f32 v218, v214, v216
    s_add_u32 m0, s73, 134144
    s_nop 0
    buffer_load_dwordx4 v7, s[16:19], s75 offen lds
    s_add_u32 s75, s75, s72
    s_cmp_ge_u32 s75, s37
    s_cselect_b32 s75, 0, s75
    s_cmp_ge_u32 s2, 224
    s_cbranch_scc1 W13F
    s_cmp_lt_u32 s4, 4
    s_cbranch_scc1 W18F
    s_waitcnt vmcnt(15)
    s_branch W18F
W13F:
    s_waitcnt vmcnt(13)
W18F:
    s_waitcnt vmcnt(18) lgkmcnt(0)
    s_barrier
    v_mfma_f32_32x32x16_bf16 v[32:47], v[200:203], v[184:187], v[32:47]
    ds_read_b64_tr_b16 v[176:177], v12 offset:32768
    v_accvgpr_write_b32 a155, v217
    v_cndmask_b32 v218, v218, v211, s[64:65]
    v_mfma_f32_32x32x16_bf16 v[48:63], v[204:207], v[184:187], v[48:63]
    ds_read_b64_tr_b16 v[178:179], v12 offset:33792
    v_accvgpr_write_b32 a159, v218
    v_fract_f32 v209, v209
    s_add_u32 m0, s73, 0
    s_nop 0
    buffer_load_dwordx4 v2, s[8:11], s74 offen lds
    v_mfma_f32_32x32x16_bf16 v[64:79], v[200:203], v[188:191], v[64:79]
    ds_read_b64_tr_b16 v[180:181], v12 offset:49152
    v_add_f32 v212, v209, v208
    v_cos_f32 v213, v209
    v_mfma_f32_32x32x16_bf16 v[80:95], v[204:207], v[188:191], v[80:95]
    ds_read_b64_tr_b16 v[182:183], v12 offset:50176
    v_sin_f32 v214, -v209
    v_add_f32 v209, v212, v208
    s_add_u32 m0, s73, 1024
    s_nop 0
    buffer_load_dwordx4 v3, s[8:11], s74 offen lds
    v_mfma_f32_32x32x16_bf16 v[96:111], v[200:203], v[192:195], v[96:111]
    ds_read_b128 v[160:163], v8 offset:16384
    v_cos_f32 v215, v212
    v_sin_f32 v216, -v212
    v_mfma_f32_32x32x16_bf16 v[112:127], v[204:207], v[192:195], v[112:127]
    ds_read_b128 v[164:167], v8 offset:20480
    v_cvt_pk_bf16_f32 v217, v213, v215
    v_cvt_pk_bf16_f32 v218, v214, v216
    s_add_u32 m0, s73, 2048
    s_nop 0
    buffer_load_dwordx4 v4, s[8:11], s74 offen lds
    v_mfma_f32_32x32x16_bf16 v[128:143], v[200:203], v[196:199], v[128:143]
    ds_read_b128 v[168:171], v8 offset:24576
    v_accvgpr_write_b32 a160, v217
    v_cndmask_b32 v218, v218, v211, s[64:65]
    v_mfma_f32_32x32x16_bf16 v[144:159], v[204:207], v[196:199], v[144:159]
    ds_read_b128 v[172:175], v8 offset:28672
    v_accvgpr_write_b32 a164, v218
    v_add_f32 v212, v209, v208
    s_add_u32 m0, s73, 3072
    s_nop 0
    buffer_load_dwordx4 v5, s[8:11], s74 offen lds
    s_add_u32 s74, s74, 128
    s_and_b32 s74, s74, 0x3ff
    s_waitcnt lgkmcnt(0)
    v_mfma_f32_32x32x16_bf16 v[32:47], v[176:179], v[160:163], v[32:47]
    ds_read_b64_tr_b16 v[200:201], v12 offset:36864
    v_cos_f32 v213, v209
    v_sin_f32 v214, -v209
    v_mfma_f32_32x32x16_bf16 v[48:63], v[180:183], v[160:163], v[48:63]
    ds_read_b64_tr_b16 v[202:203], v12 offset:37888
    v_add_f32 v209, v212, v208
    v_cos_f32 v215, v212
    s_add_u32 m0, s73, 49152
    s_nop 0
    buffer_load_dwordx4 v6, s[12:15], s75 offen lds
    v_mfma_f32_32x32x16_bf16 v[64:79], v[176:179], v[164:167], v[64:79]
    ds_read_b64_tr_b16 v[204:205], v12 offset:53248
    v_sin_f32 v216, -v212
    v_cvt_pk_bf16_f32 v217, v213, v215
    v_mfma_f32_32x32x16_bf16 v[80:95], v[180:183], v[164:167], v[80:95]
    ds_read_b64_tr_b16 v[206:207], v12 offset:54272
    v_cvt_pk_bf16_f32 v218, v214, v216
    v_accvgpr_write_b32 a161, v217
    s_add_u32 m0, s73, 65536
    s_nop 0
    buffer_load_dwordx4 v7, s[16:19], s75 offen lds
    s_add_u32 s75, s75, s71
    v_mfma_f32_32x32x16_bf16 v[96:111], v[176:179], v[168:171], v[96:111]
    ds_read_b128 v[184:187], v9 offset:16384
    v_cndmask_b32 v218, v218, v211, s[64:65]
    v_accvgpr_write_b32 a165, v218
    v_mfma_f32_32x32x16_bf16 v[112:127], v[180:183], v[168:171], v[112:127]
    ds_read_b128 v[188:191], v9 offset:20480
    v_add_f32 v212, v209, v208
    v_cos_f32 v213, v209
    s_add_u32 m0, s73, 50176
    s_nop 0
    buffer_load_dwordx4 v6, s[12:15], s75 offen lds
    v_mfma_f32_32x32x16_bf16 v[128:143], v[176:179], v[172:175], v[128:143]
    ds_read_b128 v[192:195], v9 offset:24576
    v_sin_f32 v214, -v209
    v_add_f32 v209, v212, v208
    v_mfma_f32_32x32x16_bf16 v[144:159], v[180:183], v[172:175], v[144:159]
    ds_read_b128 v[196:199], v9 offset:28672
    v_cos_f32 v215, v212
    v_sin_f32 v216, -v212
    s_add_u32 m0, s73, 66560
    s_nop 0
    buffer_load_dwordx4 v7, s[16:19], s75 offen lds
    s_add_u32 s75, s75, s71
    s_waitcnt lgkmcnt(0)
    v_mfma_f32_32x32x16_bf16 v[32:47], v[200:203], v[184:187], v[32:47]
    ds_read_b64_tr_b16 v[176:177], v12 offset:40960
    v_cvt_pk_bf16_f32 v217, v213, v215
    v_cvt_pk_bf16_f32 v218, v214, v216
    v_mfma_f32_32x32x16_bf16 v[48:63], v[204:207], v[184:187], v[48:63]
    ds_read_b64_tr_b16 v[178:179], v12 offset:41984
    v_accvgpr_write_b32 a162, v217
    v_cndmask_b32 v218, v218, v211, s[64:65]
    s_add_u32 m0, s73, 51200
    s_nop 0
    buffer_load_dwordx4 v6, s[12:15], s75 offen lds
    v_mfma_f32_32x32x16_bf16 v[64:79], v[200:203], v[188:191], v[64:79]
    ds_read_b64_tr_b16 v[180:181], v12 offset:57344
    v_accvgpr_write_b32 a166, v218
    v_add_f32 v212, v209, v208
    v_mfma_f32_32x32x16_bf16 v[80:95], v[204:207], v[188:191], v[80:95]
    ds_read_b64_tr_b16 v[182:183], v12 offset:58368
    v_cos_f32 v213, v209
    v_sin_f32 v214, -v209
    s_add_u32 m0, s73, 67584
    s_nop 0
    buffer_load_dwordx4 v7, s[16:19], s75 offen lds
    s_add_u32 s75, s75, s71
    v_mfma_f32_32x32x16_bf16 v[96:111], v[200:203], v[192:195], v[96:111]
    ds_read_b128 v[160:163], v10 offset:16384
    v_add_f32 v209, v212, v210
    v_cos_f32 v215, v212
    v_mfma_f32_32x32x16_bf16 v[112:127], v[204:207], v[192:195], v[112:127]
    ds_read_b128 v[164:167], v10 offset:20480
    v_sin_f32 v216, -v212
    v_cvt_pk_bf16_f32 v217, v213, v215
    s_add_u32 m0, s73, 52224
    s_nop 0
    buffer_load_dwordx4 v6, s[12:15], s75 offen lds
    v_mfma_f32_32x32x16_bf16 v[128:143], v[200:203], v[196:199], v[128:143]
    ds_read_b128 v[168:171], v10 offset:24576
    v_cvt_pk_bf16_f32 v218, v214, v216
    v_accvgpr_write_b32 a163, v217
    v_mfma_f32_32x32x16_bf16 v[144:159], v[204:207], v[196:199], v[144:159]
    ds_read_b128 v[172:175], v10 offset:28672
    v_cndmask_b32 v218, v218, v211, s[64:65]
    v_accvgpr_write_b32 a167, v218
    s_add_u32 m0, s73, 68608
    s_nop 0
    buffer_load_dwordx4 v7, s[16:19], s75 offen lds
    s_add_u32 s75, s75, s72
    s_cmp_ge_u32 s75, s37
    s_cselect_b32 s75, 0, s75
    s_waitcnt lgkmcnt(0)
    v_mfma_f32_32x32x16_bf16 v[32:47], v[176:179], v[160:163], v[32:47]
    ds_read_b64_tr_b16 v[200:201], v12 offset:45056
    v_fract_f32 v209, v209
    v_add_f32 v212, v209, v208
    v_mfma_f32_32x32x16_bf16 v[48:63], v[180:183], v[160:163], v[48:63]
    ds_read_b64_tr_b16 v[202:203], v12 offset:46080
    v_cos_f32 v213, v209
    v_sin_f32 v214, -v209
    v_mfma_f32_32x32x16_bf16 v[64:79], v[176:179], v[164:167], v[64:79]
    ds_read_b64_tr_b16 v[204:205], v12 offset:61440
    v_add_f32 v209, v212, v208
    v_cos_f32 v215, v212
    v_mfma_f32_32x32x16_bf16 v[80:95], v[180:183], v[164:167], v[80:95]
    ds_read_b64_tr_b16 v[206:207], v12 offset:62464
    v_sin_f32 v216, -v212
    v_cvt_pk_bf16_f32 v217, v213, v215
    v_mfma_f32_32x32x16_bf16 v[96:111], v[176:179], v[168:171], v[96:111]
    ds_read_b128 v[184:187], v11 offset:16384
    v_cvt_pk_bf16_f32 v218, v214, v216
    v_accvgpr_write_b32 a168, v217
    v_mfma_f32_32x32x16_bf16 v[112:127], v[180:183], v[168:171], v[112:127]
    ds_read_b128 v[188:191], v11 offset:20480
    v_cndmask_b32 v218, v218, v211, s[64:65]
    v_accvgpr_write_b32 a172, v218
    v_mfma_f32_32x32x16_bf16 v[128:143], v[176:179], v[172:175], v[128:143]
    ds_read_b128 v[192:195], v11 offset:24576
    v_add_f32 v212, v209, v208
    v_cos_f32 v213, v209
    v_mfma_f32_32x32x16_bf16 v[144:159], v[180:183], v[172:175], v[144:159]
    ds_read_b128 v[196:199], v11 offset:28672
    v_sin_f32 v214, -v209
    v_add_f32 v209, v212, v208
    s_waitcnt vmcnt(12) lgkmcnt(0)
    s_barrier
    s_cmp_eq_u32 s3, 0
    s_cbranch_scc0 NOARRF
    s_and_b32 s36, s2, 3
    s_lshl_b32 s36, s36, 6
    v_mov_b32 v15, 1
    s_mov_b64 exec, 1
    buffer_atomic_add v15, v248, s[28:31], s36 offen sc1
    s_mov_b64 exec, -1
NOARRF:
    v_mfma_f32_32x32x16_bf16 v[32:47], v[200:203], v[184:187], v[32:47]
    ds_read_b64_tr_b16 v[176:177], v13 offset:0
    v_cos_f32 v215, v212
    v_sin_f32 v216, -v212
    v_mfma_f32_32x32x16_bf16 v[48:63], v[204:207], v[184:187], v[48:63]
    ds_read_b64_tr_b16 v[178:179], v13 offset:1024
    v_cvt_pk_bf16_f32 v217, v213, v215
    v_cvt_pk_bf16_f32 v218, v214, v216
    s_add_u32 m0, s73, 16384
    s_nop 0
    buffer_load_dwordx4 v2, s[8:11], s74 offen lds
    v_mfma_f32_32x32x16_bf16 v[64:79], v[200:203], v[188:191], v[64:79]
    ds_read_b64_tr_b16 v[180:181], v13 offset:16384
    v_accvgpr_write_b32 a169, v217
    v_cndmask_b32 v218, v218, v211, s[64:65]
    v_mfma_f32_32x32x16_bf16 v[80:95], v[204:207], v[188:191], v[80:95]
    ds_read_b64_tr_b16 v[182:183], v13 offset:17408
    v_accvgpr_write_b32 a173, v218
    v_add_f32 v212, v209, v208
    s_add_u32 m0, s73, 17408
    s_nop 0
    buffer_load_dwordx4 v3, s[8:11], s74 offen lds
    v_mfma_f32_32x32x16_bf16 v[96:111], v[200:203], v[192:195], v[96:111]
    ds_read_b128 v[160:163], v8 offset:32768
    v_cos_f32 v213, v209
    v_sin_f32 v214, -v209
    v_mfma_f32_32x32x16_bf16 v[112:127], v[204:207], v[192:195], v[112:127]
    ds_read_b128 v[164:167], v8 offset:36864
    v_add_f32 v209, v212, v208
    v_cos_f32 v215, v212
    s_add_u32 m0, s73, 18432
    s_nop 0
    buffer_load_dwordx4 v4, s[8:11], s74 offen lds
    v_mfma_f32_32x32x16_bf16 v[128:143], v[200:203], v[196:199], v[128:143]
    ds_read_b128 v[168:171], v8 offset:40960
    v_sin_f32 v216, -v212
    v_cvt_pk_bf16_f32 v217, v213, v215
    v_mfma_f32_32x32x16_bf16 v[144:159], v[204:207], v[196:199], v[144:159]
    ds_read_b128 v[172:175], v8 offset:45056
    v_cvt_pk_bf16_f32 v218, v214, v216
    v_accvgpr_write_b32 a170, v217
    s_add_u32 m0, s73, 19456
    s_nop 0
    buffer_load_dwordx4 v5, s[8:11], s74 offen lds
    s_add_u32 s74, s74, 128
    s_and_b32 s74, s74, 0x3ff
    s_waitcnt lgkmcnt(0)
    v_mfma_f32_32x32x16_bf16 v[32:47], v[176:179], v[160:163], v[32:47]
    ds_read_b64_tr_b16 v[200:201], v13 offset:4096
    v_cndmask_b32 v218, v218, v211, s[64:65]
    v_accvgpr_write_b32 a174, v218
    v_mfma_f32_32x32x16_bf16 v[48:63], v[180:183], v[160:163], v[48:63]
    ds_read_b64_tr_b16 v[202:203], v13 offset:5120
    v_add_f32 v212, v209, v208
    v_cos_f32 v213, v209
    s_add_u32 m0, s73, 81920
    s_nop 0
    buffer_load_dwordx4 v6, s[12:15], s75 offen lds
    v_mfma_f32_32x32x16_bf16 v[64:79], v[176:179], v[164:167], v[64:79]
    ds_read_b64_tr_b16 v[204:205], v13 offset:20480
    v_sin_f32 v214, -v209
    v_add_f32 v209, v212, v210
    v_mfma_f32_32x32x16_bf16 v[80:95], v[180:183], v[164:167], v[80:95]
    ds_read_b64_tr_b16 v[206:207], v13 offset:21504
    v_cos_f32 v215, v212
    v_sin_f32 v216, -v212
    s_add_u32 m0, s73, 98304
    s_nop 0
    buffer_load_dwordx4 v7, s[16:19], s75 offen lds
    s_add_u32 s75, s75, s71
    v_mfma_f32_32x32x16_bf16 v[96:111], v[176:179], v[168:171], v[96:111]
    ds_read_b128 v[184:187], v9 offset:32768
    v_cvt_pk_bf16_f32 v217, v213, v215
    v_cvt_pk_bf16_f32 v218, v214, v216
    v_mfma_f32_32x32x16_bf16 v[112:127], v[180:183], v[168:171], v[112:127]
    ds_read_b128 v[188:191], v9 offset:36864
    v_accvgpr_write_b32 a171, v217
    v_cndmask_b32 v218, v218, v211, s[64:65]
    s_add_u32 m0, s73, 82944
    s_nop 0
    buffer_load_dwordx4 v6, s[12:15], s75 offen lds
    v_mfma_f32_32x32x16_bf16 v[128:143], v[176:179], v[172:175], v[128:143]
    ds_read_b128 v[192:195], v9 offset:40960
    v_accvgpr_write_b32 a175, v218
    v_fract_f32 v209, v209
    v_mfma_f32_32x32x16_bf16 v[144:159], v[180:183], v[172:175], v[144:159]
    ds_read_b128 v[196:199], v9 offset:45056
    v_add_f32 v212, v209, v208
    v_cos_f32 v213, v209
    s_add_u32 m0, s73, 99328
    s_nop 0
    buffer_load_dwordx4 v7, s[16:19], s75 offen lds
    s_add_u32 s75, s75, s71
    s_waitcnt lgkmcnt(0)
    v_mfma_f32_32x32x16_bf16 v[32:47], v[200:203], v[184:187], v[32:47]
    ds_read_b64_tr_b16 v[176:177], v13 offset:8192
    v_sin_f32 v214, -v209
    v_add_f32 v209, v212, v208
    v_mfma_f32_32x32x16_bf16 v[48:63], v[204:207], v[184:187], v[48:63]
    ds_read_b64_tr_b16 v[178:179], v13 offset:9216
    v_cos_f32 v215, v212
    v_sin_f32 v216, -v212
    s_add_u32 m0, s73, 83968
    s_nop 0
    buffer_load_dwordx4 v6, s[12:15], s75 offen lds
    v_mfma_f32_32x32x16_bf16 v[64:79], v[200:203], v[188:191], v[64:79]
    ds_read_b64_tr_b16 v[180:181], v13 offset:24576
    v_cvt_pk_bf16_f32 v217, v213, v215
    v_cvt_pk_bf16_f32 v218, v214, v216
    v_mfma_f32_32x32x16_bf16 v[80:95], v[204:207], v[188:191], v[80:95]
    ds_read_b64_tr_b16 v[182:183], v13 offset:25600
    v_accvgpr_write_b32 a176, v217
    v_cndmask_b32 v218, v218, v211, s[64:65]
    s_add_u32 m0, s73, 100352
    s_nop 0
    buffer_load_dwordx4 v7, s[16:19], s75 offen lds
    s_add_u32 s75, s75, s71
    v_mfma_f32_32x32x16_bf16 v[96:111], v[200:203], v[192:195], v[96:111]
    ds_read_b128 v[160:163], v10 offset:32768
    v_accvgpr_write_b32 a180, v218
    v_add_f32 v212, v209, v208
    v_mfma_f32_32x32x16_bf16 v[112:127], v[204:207], v[192:195], v[112:127]
    ds_read_b128 v[164:167], v10 offset:36864
    v_cos_f32 v213, v209
    v_sin_f32 v214, -v209
    s_add_u32 m0, s73, 84992
    s_nop 0
    buffer_load_dwordx4 v6, s[12:15], s75 offen lds
    v_mfma_f32_32x32x16_bf16 v[128:143], v[200:203], v[196:199], v[128:143]
    ds_read_b128 v[168:171], v10 offset:40960
    v_add_f32 v209, v212, v208
    v_cos_f32 v215, v212
    v_mfma_f32_32x32x16_bf16 v[144:159], v[204:207], v[196:199], v[144:159]
    ds_read_b128 v[172:175], v10 offset:45056
    v_sin_f32 v216, -v212
    v_cvt_pk_bf16_f32 v217, v213, v215
    s_add_u32 m0, s73, 101376
    s_nop 0
    buffer_load_dwordx4 v7, s[16:19], s75 offen lds
    s_add_u32 s75, s75, s72
    s_cmp_ge_u32 s75, s37
    s_cselect_b32 s75, 0, s75
    s_waitcnt lgkmcnt(0)
    v_mfma_f32_32x32x16_bf16 v[32:47], v[176:179], v[160:163], v[32:47]
    ds_read_b64_tr_b16 v[200:201], v13 offset:12288
    v_cvt_pk_bf16_f32 v218, v214, v216
    v_accvgpr_write_b32 a177, v217
    v_mfma_f32_32x32x16_bf16 v[48:63], v[180:183], v[160:163], v[48:63]
    ds_read_b64_tr_b16 v[202:203], v13 offset:13312
    v_cndmask_b32 v218, v218, v211, s[64:65]
    v_accvgpr_write_b32 a181, v218
    v_mfma_f32_32x32x16_bf16 v[64:79], v[176:179], v[164:167], v[64:79]
    ds_read_b64_tr_b16 v[204:205], v13 offset:28672
    v_add_f32 v212, v209, v208
    v_cos_f32 v213, v209
    v_mfma_f32_32x32x16_bf16 v[80:95], v[180:183], v[164:167], v[80:95]
    ds_read_b64_tr_b16 v[206:207], v13 offset:29696
    v_sin_f32 v214, -v209
    v_add_f32 v209, v212, v208
    v_mfma_f32_32x32x16_bf16 v[96:111], v[176:179], v[168:171], v[96:111]
    ds_read_b128 v[184:187], v11 offset:32768
    v_cos_f32 v215, v212
    v_sin_f32 v216, -v212
    v_mfma_f32_32x32x16_bf16 v[112:127], v[180:183], v[168:171], v[112:127]
    ds_read_b128 v[188:191], v11 offset:36864
    v_cvt_pk_bf16_f32 v217, v213, v215
    v_cvt_pk_bf16_f32 v218, v214, v216
    v_mfma_f32_32x32x16_bf16 v[128:143], v[176:179], v[172:175], v[128:143]
    ds_read_b128 v[192:195], v11 offset:40960
    v_accvgpr_write_b32 a178, v217
    v_cndmask_b32 v218, v218, v211, s[64:65]
    v_mfma_f32_32x32x16_bf16 v[144:159], v[180:183], v[172:175], v[144:159]
    ds_read_b128 v[196:199], v11 offset:45056
    v_accvgpr_write_b32 a182, v218
    v_add_f32 v212, v209, v208
    s_waitcnt vmcnt(12) lgkmcnt(0)
    s_barrier
    v_mfma_f32_32x32x16_bf16 v[32:47], v[200:203], v[184:187], v[32:47]
    ds_read_b64_tr_b16 v[176:177], v12 offset:0
    v_cos_f32 v213, v209
    v_sin_f32 v214, -v209
    v_mfma_f32_32x32x16_bf16 v[48:63], v[204:207], v[184:187], v[48:63]
    ds_read_b64_tr_b16 v[178:179], v12 offset:1024
    v_add_f32 v209, v212, v210
    v_cos_f32 v215, v212
    s_add_u32 m0, s73, 32768
    s_nop 0
    buffer_load_dwordx4 v2, s[8:11], s74 offen lds
    v_mfma_f32_32x32x16_bf16 v[64:79], v[200:203], v[188:191], v[64:79]
    ds_read_b64_tr_b16 v[180:181], v12 offset:16384
    v_sin_f32 v216, -v212
    v_cvt_pk_bf16_f32 v217, v213, v215
    v_mfma_f32_32x32x16_bf16 v[80:95], v[204:207], v[188:191], v[80:95]
    ds_read_b64_tr_b16 v[182:183], v12 offset:17408
    v_cvt_pk_bf16_f32 v218, v214, v216
    v_accvgpr_write_b32 a179, v217
    s_add_u32 m0, s73, 33792
    s_nop 0
    buffer_load_dwordx4 v3, s[8:11], s74 offen lds
    v_mfma_f32_32x32x16_bf16 v[96:111], v[200:203], v[192:195], v[96:111]
    ds_read_b128 v[160:163], v8 offset:0
    v_cndmask_b32 v218, v218, v211, s[64:65]
    v_accvgpr_write_b32 a183, v218
    v_mfma_f32_32x32x16_bf16 v[112:127], v[204:207], v[192:195], v[112:127]
    ds_read_b128 v[164:167], v8 offset:4096
    v_fract_f32 v209, v209
    v_add_f32 v212, v209, v208
    s_add_u32 m0, s73, 34816
    s_nop 0
    buffer_load_dwordx4 v4, s[8:11], s74 offen lds
    v_mfma_f32_32x32x16_bf16 v[128:143], v[200:203], v[196:199], v[128:143]
    ds_read_b128 v[168:171], v8 offset:8192
    v_cos_f32 v213, v209
    v_sin_f32 v214, -v209
    v_mfma_f32_32x32x16_bf16 v[144:159], v[204:207], v[196:199], v[144:159]
    ds_read_b128 v[172:175], v8 offset:12288
    v_add_f32 v209, v212, v208
    v_cos_f32 v215, v212
    s_add_u32 m0, s73, 35840
    s_nop 0
    buffer_load_dwordx4 v5, s[8:11], s74 offen lds
    s_add_u32 s74, s74, 128
    s_and_b32 s74, s74, 0x3ff
    s_waitcnt lgkmcnt(0)
    v_mfma_f32_32x32x16_bf16 v[32:47], v[176:179], v[160:163], v[32:47]
    ds_read_b64_tr_b16 v[200:201], v12 offset:4096
    v_sin_f32 v216, -v212
    v_cvt_pk_bf16_f32 v217, v213, v215
    v_mfma_f32_32x32x16_bf16 v[48:63], v[180:183], v[160:163], v[48:63]
    ds_read_b64_tr_b16 v[202:203], v12 offset:5120
    v_cvt_pk_bf16_f32 v218, v214, v216
    v_accvgpr_write_b32 a184, v217
    s_add_u32 m0, s73, 114688
    s_nop 0
    buffer_load_dwordx4 v6, s[12:15], s75 offen lds
    v_mfma_f32_32x32x16_bf16 v[64:79], v[176:179], v[164:167], v[64:79]
    ds_read_b64_tr_b16 v[204:205], v12 offset:20480
    v_cndmask_b32 v218, v218, v211, s[64:65]
    v_accvgpr_write_b32 a188, v218
    v_mfma_f32_32x32x16_bf16 v[80:95], v[180:183], v[164:167], v[80:95]
    ds_read_b64_tr_b16 v[206:207], v12 offset:21504
    v_add_f32 v212, v209, v208
    v_cos_f32 v213, v209
    s_add_u32 m0, s73, 131072
    s_nop 0
    buffer_load_dwordx4 v7, s[16:19], s75 offen lds
    s_add_u32 s75, s75, s71
    v_mfma_f32_32x32x16_bf16 v[96:111], v[176:179], v[168:171], v[96:111]
    ds_read_b128 v[184:187], v9 offset:0
    v_sin_f32 v214, -v209
    v_add_f32 v209, v212, v208
    v_mfma_f32_32x32x16_bf16 v[112:127], v[180:183], v[168:171], v[112:127]
    ds_read_b128 v[188:191], v9 offset:4096
    v_cos_f32 v215, v212
    v_sin_f32 v216, -v212
    s_add_u32 m0, s73, 115712
    s_nop 0
    buffer_load_dwordx4 v6, s[12:15], s75 offen lds
    v_mfma_f32_32x32x16_bf16 v[128:143], v[176:179], v[172:175], v[128:143]
    ds_read_b128 v[192:195], v9 offset:8192
    v_cvt_pk_bf16_f32 v217, v213, v215
    v_cvt_pk_bf16_f32 v218, v214, v216
    v_mfma_f32_32x32x16_bf16 v[144:159], v[180:183], v[172:175], v[144:159]
    ds_read_b128 v[196:199], v9 offset:12288
    v_accvgpr_write_b32 a185, v217
    v_cndmask_b32 v218, v218, v211, s[64:65]
    s_add_u32 m0, s73, 132096
    s_nop 0
    buffer_load_dwordx4 v7, s[16:19], s75 offen lds
    s_add_u32 s75, s75, s71
    s_waitcnt lgkmcnt(0)
    v_mfma_f32_32x32x16_bf16 v[32:47], v[200:203], v[184:187], v[32:47]
    ds_read_b64_tr_b16 v[176:177], v12 offset:8192
    v_accvgpr_write_b32 a189, v218
    v_add_f32 v212, v209, v208
    v_mfma_f32_32x32x16_bf16 v[48:63], v[204:207], v[184:187], v[48:63]
    ds_read_b64_tr_b16 v[178:179], v12 offset:9216
    v_cos_f32 v213, v209
    v_sin_f32 v214, -v209
    s_add_u32 m0, s73, 116736
    s_nop 0
    buffer_load_dwordx4 v6, s[12:15], s75 offen lds
    v_mfma_f32_32x32x16_bf16 v[64:79], v[200:203], v[188:191], v[64:79]
    ds_read_b64_tr_b16 v[180:181], v12 offset:24576
    v_add_f32 v209, v212, v208
    v_cos_f32 v215, v212
    v_mfma_f32_32x32x16_bf16 v[80:95], v[204:207], v[188:191], v[80:95]
    ds_read_b64_tr_b16 v[182:183], v12 offset:25600
    v_sin_f32 v216, -v212
    v_cvt_pk_bf16_f32 v217, v213, v215
    s_add_u32 m0, s73, 133120
    s_nop 0
    buffer_load_dwordx4 v7, s[16:19], s75 offen lds
    s_add_u32 s75, s75, s71
    v_mfma_f32_32x32x16_bf16 v[96:111], v[200:203], v[192:195], v[96:111]
    ds_read_b128 v[160:163], v10 offset:0
    v_cvt_pk_bf16_f32 v218, v214, v216
    v_accvgpr_write_b32 a186, v217
    v_mfma_f32_32x32x16_bf16 v[112:127], v[204:207], v[192:195], v[112:127]
    ds_read_b128 v[164:167], v10 offset:4096
    v_cndmask_b32 v218, v218, v211, s[64:65]
    v_accvgpr_write_b32 a190, v218
    s_add_u32 m0, s73, 117760
    s_nop 0
    buffer_load_dwordx4 v6, s[12:15], s75 offen lds
    v_mfma_f32_32x32x16_bf16 v[128:143], v[200:203], v[196:199], v[128:143]
    ds_read_b128 v[168:171], v10 offset:8192
    v_add_f32 v212, v209, v208
    v_cos_f32 v213, v209
    v_mfma_f32_32x32x16_bf16 v[144:159], v[204:207], v[196:199], v[144:159]
    ds_read_b128 v[172:175], v10 offset:12288
    v_sin_f32 v214, -v209
    v_add_f32 v209, v212, v210
    s_add_u32 m0, s73, 134144
    s_nop 0
    buffer_load_dwordx4 v7, s[16:19], s75 offen lds
    s_add_u32 s75, s75, s72
    s_cmp_ge_u32 s75, s37
    s_cselect_b32 s75, 0, s75
    s_waitcnt lgkmcnt(0)
    v_mfma_f32_32x32x16_bf16 v[32:47], v[176:179], v[160:163], v[32:47]
    ds_read_b64_tr_b16 v[200:201], v12 offset:12288
    v_cos_f32 v215, v212
    v_sin_f32 v216, -v212
    v_mfma_f32_32x32x16_bf16 v[48:63], v[180:183], v[160:163], v[48:63]
    ds_read_b64_tr_b16 v[202:203], v12 offset:13312
    v_cvt_pk_bf16_f32 v217, v213, v215
    v_cvt_pk_bf16_f32 v218, v214, v216
    v_mfma_f32_32x32x16_bf16 v[64:79], v[176:179], v[164:167], v[64:79]
    ds_read_b64_tr_b16 v[204:205], v12 offset:28672
    v_accvgpr_write_b32 a187, v217
    v_cndmask_b32 v218, v218, v211, s[64:65]
    v_mfma_f32_32x32x16_bf16 v[80:95], v[180:183], v[164:167], v[80:95]
    ds_read_b64_tr_b16 v[206:207], v12 offset:29696
    v_accvgpr_write_b32 a191, v218
    v_fract_f32 v209, v209
    v_mfma_f32_32x32x16_bf16 v[96:111], v[176:179], v[168:171], v[96:111]
    ds_read_b128 v[184:187], v11 offset:0
    v_add_f32 v212, v209, v208
    v_cos_f32 v213, v209
    v_mfma_f32_32x32x16_bf16 v[112:127], v[180:183], v[168:171], v[112:127]
    ds_read_b128 v[188:191], v11 offset:4096
    v_sin_f32 v214, -v209
    v_add_f32 v209, v212, v208
    v_mfma_f32_32x32x16_bf16 v[128:143], v[176:179], v[172:175], v[128:143]
    ds_read_b128 v[192:195], v11 offset:8192
    v_cos_f32 v215, v212
    v_sin_f32 v216, -v212
    v_mfma_f32_32x32x16_bf16 v[144:159], v[180:183], v[172:175], v[144:159]
    ds_read_b128 v[196:199], v11 offset:12288
    v_cvt_pk_bf16_f32 v217, v213, v215
    v_cvt_pk_bf16_f32 v218, v214, v216
    s_waitcnt vmcnt(12) lgkmcnt(0)
    s_barrier
    v_mfma_f32_32x32x16_bf16 v[32:47], v[200:203], v[184:187], v[32:47]
    ds_read_b64_tr_b16 v[176:177], v12 offset:32768
    v_accvgpr_write_b32 a192, v217
    v_cndmask_b32 v218, v218, v211, s[64:65]
    v_mfma_f32_32x32x16_bf16 v[48:63], v[204:207], v[184:187], v[48:63]
    ds_read_b64_tr_b16 v[178:179], v12 offset:33792
    v_accvgpr_write_b32 a196, v218
    v_add_f32 v212, v209, v208
    s_add_u32 m0, s73, 0
    s_nop 0
    buffer_load_dwordx4 v2, s[8:11], s74 offen lds
    v_mfma_f32_32x32x16_bf16 v[64:79], v[200:203], v[188:191], v[64:79]
    ds_read_b64_tr_b16 v[180:181], v12 offset:49152
    v_cos_f32 v213, v209
    v_sin_f32 v214, -v209
    v_mfma_f32_32x32x16_bf16 v[80:95], v[204:207], v[188:191], v[80:95]
    ds_read_b64_tr_b16 v[182:183], v12 offset:50176
    v_add_f32 v209, v212, v208
    v_cos_f32 v215, v212
    s_add_u32 m0, s73, 1024
    s_nop 0
    buffer_load_dwordx4 v3, s[8:11], s74 offen lds
    v_mfma_f32_32x32x16_bf16 v[96:111], v[200:203], v[192:195], v[96:111]
    ds_read_b128 v[160:163], v8 offset:16384
    v_sin_f32 v216, -v212
    v_cvt_pk_bf16_f32 v217, v213, v215
    v_mfma_f32_32x32x16_bf16 v[112:127], v[204:207], v[192:195], v[112:127]
    ds_read_b128 v[164:167], v8 offset:20480
    v_cvt_pk_bf16_f32 v218, v214, v216
    v_accvgpr_write_b32 a193, v217
    s_add_u32 m0, s73, 2048
    s_nop 0
    buffer_load_dwordx4 v4, s[8:11], s74 offen lds
    v_mfma_f32_32x32x16_bf16 v[128:143], v[200:203], v[196:199], v[128:143]
    ds_read_b128 v[168:171], v8 offset:24576
    v_cndmask_b32 v218, v218, v211, s[64:65]
    v_accvgpr_write_b32 a197, v218
    v_mfma_f32_32x32x16_bf16 v[144:159], v[204:207], v[196:199], v[144:159]
    ds_read_b128 v[172:175], v8 offset:28672
    v_add_f32 v212, v209, v208
    v_cos_f32 v213, v209
    s_add_u32 m0, s73, 3072
    s_nop 0
    buffer_load_dwordx4 v5, s[8:11], s74 offen lds
    s_add_u32 s74, s74, 128
    s_and_b32 s74, s74, 0x3ff
    s_waitcnt lgkmcnt(0)
    v_mfma_f32_32x32x16_bf16 v[32:47], v[176:179], v[160:163], v[32:47]
    ds_read_b64_tr_b16 v[200:201], v12 offset:36864
    v_sin_f32 v214, -v209
    v_add_f32 v209, v212, v208
    v_mfma_f32_32x32x16_bf16 v[48:63], v[180:183], v[160:163], v[48:63]
    ds_read_b64_tr_b16 v[202:203], v12 offset:37888
    v_cos_f32 v215, v212
    v_sin_f32 v216, -v212
    s_add_u32 m0, s73, 49152
    s_nop 0
    buffer_load_dwordx4 v6, s[12:15], s75 offen lds
    v_mfma_f32_32x32x16_bf16 v[64:79], v[176:179], v[164:167], v[64:79]
    ds_read_b64_tr_b16 v[204:205], v12 offset:53248
    v_cvt_pk_bf16_f32 v217, v213, v215
    v_cvt_pk_bf16_f32 v218, v214, v216
    v_mfma_f32_32x32x16_bf16 v[80:95], v[180:183], v[164:167], v[80:95]
    ds_read_b64_tr_b16 v[206:207], v12 offset:54272
    v_accvgpr_write_b32 a194, v217
    v_cndmask_b32 v218, v218, v211, s[64:65]
    s_add_u32 m0, s73, 65536
    s_nop 0
    buffer_load_dwordx4 v7, s[16:19], s75 offen lds
    s_add_u32 s75, s75, s71
    v_mfma_f32_32x32x16_bf16 v[96:111], v[176:179], v[168:171], v[96:111]
    ds_read_b128 v[184:187], v9 offset:16384
    v_accvgpr_write_b32 a198, v218
    v_add_f32 v212, v209, v208
    v_mfma_f32_32x32x16_bf16 v[112:127], v[180:183], v[168:171], v[112:127]
    ds_read_b128 v[188:191], v9 offset:20480
    v_cos_f32 v213, v209
    v_sin_f32 v214, -v209
    s_add_u32 m0, s73, 50176
    s_nop 0
    buffer_load_dwordx4 v6, s[12:15], s75 offen lds
    v_mfma_f32_32x32x16_bf16 v[128:143], v[176:179], v[172:175], v[128:143]
    ds_read_b128 v[192:195], v9 offset:24576
    v_add_f32 v209, v212, v210
    v_cos_f32 v215, v212
    v_mfma_f32_32x32x16_bf16 v[144:159], v[180:183], v[172:175], v[144:159]
    ds_read_b128 v[196:199], v9 offset:28672
    v_sin_f32 v216, -v212
    v_cvt_pk_bf16_f32 v217, v213, v215
    s_add_u32 m0, s73, 66560
    s_nop 0
    buffer_load_dwordx4 v7, s[16:19], s75 offen lds
    s_add_u32 s75, s75, s71
    s_waitcnt lgkmcnt(0)
    v_mfma_f32_32x32x16_bf16 v[32:47], v[200:203], v[184:187], v[32:47]
    ds_read_b64_tr_b16 v[176:177], v12 offset:40960
    v_cvt_pk_bf16_f32 v218, v214, v216
    v_accvgpr_write_b32 a195, v217
    v_mfma_f32_32x32x16_bf16 v[48:63], v[204:207], v[184:187], v[48:63]
    ds_read_b64_tr_b16 v[178:179], v12 offset:41984
    v_cndmask_b32 v218, v218, v211, s[64:65]
    v_accvgpr_write_b32 a199, v218
    s_add_u32 m0, s73, 51200
    s_nop 0
    buffer_load_dwordx4 v6, s[12:15], s75 offen lds
    v_mfma_f32_32x32x16_bf16 v[64:79], v[200:203], v[188:191], v[64:79]
    ds_read_b64_tr_b16 v[180:181], v12 offset:57344
    v_fract_f32 v209, v209
    v_add_f32 v212, v209, v208
    v_mfma_f32_32x32x16_bf16 v[80:95], v[204:207], v[188:191], v[80:95]
    ds_read_b64_tr_b16 v[182:183], v12 offset:58368
    v_cos_f32 v213, v209
    v_sin_f32 v214, -v209
    s_add_u32 m0, s73, 67584
    s_nop 0
    buffer_load_dwordx4 v7, s[16:19], s75 offen lds
    s_add_u32 s75, s75, s71
    v_mfma_f32_32x32x16_bf16 v[96:111], v[200:203], v[192:195], v[96:111]
    ds_read_b128 v[160:163], v10 offset:16384
    v_add_f32 v209, v212, v208
    v_cos_f32 v215, v212
    v_mfma_f32_32x32x16_bf16 v[112:127], v[204:207], v[192:195], v[112:127]
    ds_read_b128 v[164:167], v10 offset:20480
    v_sin_f32 v216, -v212
    v_cvt_pk_bf16_f32 v217, v213, v215
    s_add_u32 m0, s73, 52224
    s_nop 0
    buffer_load_dwordx4 v6, s[12:15], s75 offen lds
    v_mfma_f32_32x32x16_bf16 v[128:143], v[200:203], v[196:199], v[128:143]
    ds_read_b128 v[168:171], v10 offset:24576
    v_cvt_pk_bf16_f32 v218, v214, v216
    v_accvgpr_write_b32 a200, v217
    v_mfma_f32_32x32x16_bf16 v[144:159], v[204:207], v[196:199], v[144:159]
    ds_read_b128 v[172:175], v10 offset:28672
    v_cndmask_b32 v218, v218, v211, s[64:65]
    v_accvgpr_write_b32 a204, v218
    s_add_u32 m0, s73, 68608
    s_nop 0
    buffer_load_dwordx4 v7, s[16:19], s75 offen lds
    s_add_u32 s75, s75, s72
    s_cmp_ge_u32 s75, s37
    s_cselect_b32 s75, 0, s75
    s_waitcnt lgkmcnt(0)
    v_mfma_f32_32x32x16_bf16 v[32:47], v[176:179], v[160:163], v[32:47]
    ds_read_b64_tr_b16 v[200:201], v12 offset:45056
    v_add_f32 v212, v209, v208
    v_cos_f32 v213, v209
    v_mfma_f32_32x32x16_bf16 v[48:63], v[180:183], v[160:163], v[48:63]
    ds_read_b64_tr_b16 v[202:203], v12 offset:46080
    v_sin_f32 v214, -v209
    v_add_f32 v209, v212, v208
    v_mfma_f32_32x32x16_bf16 v[64:79], v[176:179], v[164:167], v[64:79]
    ds_read_b64_tr_b16 v[204:205], v12 offset:61440
    v_cos_f32 v215, v212
    v_sin_f32 v216, -v212
    v_mfma_f32_32x32x16_bf16 v[80:95], v[180:183], v[164:167], v[80:95]
    ds_read_b64_tr_b16 v[206:207], v12 offset:62464
    v_cvt_pk_bf16_f32 v217, v213, v215
    v_cvt_pk_bf16_f32 v218, v214, v216
    v_mfma_f32_32x32x16_bf16 v[96:111], v[176:179], v[168:171], v[96:111]
    ds_read_b128 v[184:187], v11 offset:16384
    v_accvgpr_write_b32 a201, v217
    v_cndmask_b32 v218, v218, v211, s[64:65]
    v_mfma_f32_32x32x16_bf16 v[112:127], v[180:183], v[168:171], v[112:127]
    ds_read_b128 v[188:191], v11 offset:20480
    v_accvgpr_write_b32 a205, v218
    v_add_f32 v212, v209, v208
    v_mfma_f32_32x32x16_bf16 v[128:143], v[176:179], v[172:175], v[128:143]
    ds_read_b128 v[192:195], v11 offset:24576
    v_cos_f32 v213, v209
    v_sin_f32 v214, -v209
    v_mfma_f32_32x32x16_bf16 v[144:159], v[180:183], v[172:175], v[144:159]
    ds_read_b128 v[196:199], v11 offset:28672
    v_add_f32 v209, v212, v208
    v_cos_f32 v215, v212
    s_waitcnt vmcnt(12) lgkmcnt(0)
    s_barrier
    buffer_load_dword v15, v14, s[28:31], 0 offen sc1
    v_mfma_f32_32x32x16_bf16 v[32:47], v[200:203], v[184:187], v[32:47]
    ds_read_b64_tr_b16 v[176:177], v13 offset:0
    v_sin_f32 v216, -v212
    v_cvt_pk_bf16_f32 v217, v213, v215
    v_mfma_f32_32x32x16_bf16 v[48:63], v[204:207], v[184:187], v[48:63]
    ds_read_b64_tr_b16 v[178:179], v13 offset:1024
    v_cvt_pk_bf16_f32 v218, v214, v216
    v_accvgpr_write_b32 a202, v217
    s_add_u32 m0, s73, 16384
    s_nop 0
    buffer_load_dwordx4 v2, s[8:11], s74 offen lds
    v_mfma_f32_32x32x16_bf16 v[64:79], v[200:203], v[188:191], v[64:79]
    ds_read_b64_tr_b16 v[180:181], v13 offset:16384
    v_cndmask_b32 v218, v218, v211, s[64:65]
    v_accvgpr_write_b32 a206, v218
    v_mfma_f32_32x32x16_bf16 v[80:95], v[204:207], v[188:191], v[80:95]
    ds_read_b64_tr_b16 v[182:183], v13 offset:17408
    v_add_f32 v212, v209, v208
    v_cos_f32 v213, v209
    s_add_u32 m0, s73, 17408
    s_nop 0
    buffer_load_dwordx4 v3, s[8:11], s74 offen lds
    v_mfma_f32_32x32x16_bf16 v[96:111], v[200:203], v[192:195], v[96:111]
    ds_read_b128 v[160:163], v8 offset:32768
    v_sin_f32 v214, -v209
    v_add_f32 v209, v212, v210
    v_mfma_f32_32x32x16_bf16 v[112:127], v[204:207], v[192:195], v[112:127]
    ds_read_b128 v[164:167], v8 offset:36864
    v_cos_f32 v215, v212
    v_sin_f32 v216, -v212
    s_add_u32 m0, s73, 18432
    s_nop 0
    buffer_load_dwordx4 v4, s[8:11], s74 offen lds
    v_mfma_f32_32x32x16_bf16 v[128:143], v[200:203], v[196:199], v[128:143]
    ds_read_b128 v[168:171], v8 offset:40960
    v_cvt_pk_bf16_f32 v217, v213, v215
    v_cvt_pk_bf16_f32 v218, v214, v216
    v_mfma_f32_32x32x16_bf16 v[144:159], v[204:207], v[196:199], v[144:159]
    ds_read_b128 v[172:175], v8 offset:45056
    v_accvgpr_write_b32 a203, v217
    v_cndmask_b32 v218, v218, v211, s[64:65]
    s_add_u32 m0, s73, 19456
    s_nop 0
    buffer_load_dwordx4 v5, s[8:11], s74 offen lds
    s_add_u32 s74, s74, 128
    s_and_b32 s74, s74, 0x3ff
    s_waitcnt lgkmcnt(0)
    v_mfma_f32_32x32x16_bf16 v[32:47], v[176:179], v[160:163], v[32:47]
    ds_read_b64_tr_b16 v[200:201], v13 offset:4096
    v_accvgpr_write_b32 a207, v218
    v_fract_f32 v209, v209
    v_mfma_f32_32x32x16_bf16 v[48:63], v[180:183], v[160:163], v[48:63]
    ds_read_b64_tr_b16 v[202:203], v13 offset:5120
    v_add_f32 v212, v209, v208
    v_cos_f32 v213, v209
    s_add_u32 m0, s73, 81920
    s_nop 0
    buffer_load_dwordx4 v6, s[12:15], s75 offen lds
    v_mfma_f32_32x32x16_bf16 v[64:79], v[176:179], v[164:167], v[64:79]
    ds_read_b64_tr_b16 v[204:205], v13 offset:20480
    v_sin_f32 v214, -v209
    v_add_f32 v209, v212, v208
    v_mfma_f32_32x32x16_bf16 v[80:95], v[180:183], v[164:167], v[80:95]
    ds_read_b64_tr_b16 v[206:207], v13 offset:21504
    v_cos_f32 v215, v212
    v_sin_f32 v216, -v212
    s_add_u32 m0, s73, 98304
    s_nop 0
    buffer_load_dwordx4 v7, s[16:19], s75 offen lds
    s_add_u32 s75, s75, s71
    v_mfma_f32_32x32x16_bf16 v[96:111], v[176:179], v[168:171], v[96:111]
    ds_read_b128 v[184:187], v9 offset:32768
    v_cvt_pk_bf16_f32 v217, v213, v215
    v_cvt_pk_bf16_f32 v218, v214, v216
    v_mfma_f32_32x32x16_bf16 v[112:127], v[180:183], v[168:171], v[112:127]
    ds_read_b128 v[188:191], v9 offset:36864
    v_accvgpr_write_b32 a208, v217
    v_cndmask_b32 v218, v218, v211, s[64:65]
    s_add_u32 m0, s73, 82944
    s_nop 0
    buffer_load_dwordx4 v6, s[12:15], s75 offen lds
    v_mfma_f32_32x32x16_bf16 v[128:143], v[176:179], v[172:175], v[128:143]
    ds_read_b128 v[192:195], v9 offset:40960
    v_accvgpr_write_b32 a212, v218
    v_add_f32 v212, v209, v208
    v_mfma_f32_32x32x16_bf16 v[144:159], v[180:183], v[172:175], v[144:159]
    ds_read_b128 v[196:199], v9 offset:45056
    v_cos_f32 v213, v209
    v_sin_f32 v214, -v209
    s_add_u32 m0, s73, 99328
    s_nop 0
    buffer_load_dwordx4 v7, s[16:19], s75 offen lds
    s_add_u32 s75, s75, s71
    s_waitcnt lgkmcnt(0)
    v_mfma_f32_32x32x16_bf16 v[32:47], v[200:203], v[184:187], v[32:47]
    ds_read_b64_tr_b16 v[176:177], v13 offset:8192
    v_add_f32 v209, v212, v208
    v_cos_f32 v215, v212
    v_mfma_f32_32x32x16_bf16 v[48:63], v[204:207], v[184:187], v[48:63]
    ds_read_b64_tr_b16 v[178:179], v13 offset:9216
    v_sin_f32 v216, -v212
    v_cvt_pk_bf16_f32 v217, v213, v215
    s_add_u32 m0, s73, 83968
    s_nop 0
    buffer_load_dwordx4 v6, s[12:15], s75 offen lds
    v_mfma_f32_32x32x16_bf16 v[64:79], v[200:203], v[188:191], v[64:79]
    ds_read_b64_tr_b16 v[180:181], v13 offset:24576
    v_cvt_pk_bf16_f32 v218, v214, v216
    v_accvgpr_write_b32 a209, v217
    v_mfma_f32_32x32x16_bf16 v[80:95], v[204:207], v[188:191], v[80:95]
    ds_read_b64_tr_b16 v[182:183], v13 offset:25600
    v_cndmask_b32 v218, v218, v211, s[64:65]
    v_accvgpr_write_b32 a213, v218
    s_add_u32 m0, s73, 100352
    s_nop 0
    buffer_load_dwordx4 v7, s[16:19], s75 offen lds
    s_add_u32 s75, s75, s71
    v_mfma_f32_32x32x16_bf16 v[96:111], v[200:203], v[192:195], v[96:111]
    ds_read_b128 v[160:163], v10 offset:32768
    v_add_f32 v212, v209, v208
    v_cos_f32 v213, v209
    v_mfma_f32_32x32x16_bf16 v[112:127], v[204:207], v[192:195], v[112:127]
    ds_read_b128 v[164:167], v10 offset:36864
    v_sin_f32 v214, -v209
    v_add_f32 v209, v212, v208
    s_add_u32 m0, s73, 84992
    s_nop 0
    buffer_load_dwordx4 v6, s[12:15], s75 offen lds
    v_mfma_f32_32x32x16_bf16 v[128:143], v[200:203], v[196:199], v[128:143]
    ds_read_b128 v[168:171], v10 offset:40960
    v_cos_f32 v215, v212
    v_sin_f32 v216, -v212
    v_mfma_f32_32x32x16_bf16 v[144:159], v[204:207], v[196:199], v[144:159]
    ds_read_b128 v[172:175], v10 offset:45056
    v_cvt_pk_bf16_f32 v217, v213, v215
    v_cvt_pk_bf16_f32 v218, v214, v216
    s_add_u32 m0, s73, 101376
    s_nop 0
    buffer_load_dwordx4 v7, s[16:19], s75 offen lds
    s_add_u32 s75, s75, s72
    s_cmp_ge_u32 s75, s37
    s_cselect_b32 s75, 0, s75
    s_waitcnt lgkmcnt(0)
    v_mfma_f32_32x32x16_bf16 v[32:47], v[176:179], v[160:163], v[32:47]
    ds_read_b64_tr_b16 v[200:201], v13 offset:12288
    v_accvgpr_write_b32 a210, v217
    v_cndmask_b32 v218, v218, v211, s[64:65]
    v_mfma_f32_32x32x16_bf16 v[48:63], v[180:183], v[160:163], v[48:63]
    ds_read_b64_tr_b16 v[202:203], v13 offset:13312
    v_accvgpr_write_b32 a214, v218
    v_add_f32 v212, v209, v208
    v_mfma_f32_32x32x16_bf16 v[64:79], v[176:179], v[164:167], v[64:79]
    ds_read_b64_tr_b16 v[204:205], v13 offset:28672
    v_cos_f32 v213, v209
    v_sin_f32 v214, -v209
    v_mfma_f32_32x32x16_bf16 v[80:95], v[180:183], v[164:167], v[80:95]
    ds_read_b64_tr_b16 v[206:207], v13 offset:29696
    v_add_f32 v209, v212, v210
    v_cos_f32 v215, v212
    v_mfma_f32_32x32x16_bf16 v[96:111], v[176:179], v[168:171], v[96:111]
    ds_read_b128 v[184:187], v11 offset:32768
    v_sin_f32 v216, -v212
    v_cvt_pk_bf16_f32 v217, v213, v215
    v_mfma_f32_32x32x16_bf16 v[112:127], v[180:183], v[168:171], v[112:127]
    ds_read_b128 v[188:191], v11 offset:36864
    v_cvt_pk_bf16_f32 v218, v214, v216
    v_accvgpr_write_b32 a211, v217
    v_mfma_f32_32x32x16_bf16 v[128:143], v[176:179], v[172:175], v[128:143]
    ds_read_b128 v[192:195], v11 offset:40960
    v_cndmask_b32 v218, v218, v211, s[64:65]
    v_accvgpr_write_b32 a215, v218
    v_mfma_f32_32x32x16_bf16 v[144:159], v[180:183], v[172:175], v[144:159]
    ds_read_b128 v[196:199], v11 offset:45056
    v_fract_f32 v209, v209
    v_add_f32 v212, v209, v208
    s_waitcnt vmcnt(12) lgkmcnt(0)
    s_barrier
    s_mov_b32 s36, 0
C0CHKF:
    v_cmp_gt_u32 vcc, 64, v15
    s_cbranch_vccz C0OKF
    s_sleep 2
    buffer_load_dword v15, v14, s[28:31], 0 offen sc1
    s_add_u32 s36, s36, 1
    s_waitcnt vmcnt(0)
    s_cmp_lt_u32 s36, 0x40000
    s_cbranch_scc1 C0CHKF
C0OKF:
    v_mfma_f32_32x32x16_bf16 v[32:47], v[200:203], v[184:187], v[32:47]
    ds_read_b64_tr_b16 v[176:177], v12 offset:0
    v_cos_f32 v213, v209
    v_sin_f32 v214, -v209
    v_mfma_f32_32x32x16_bf16 v[48:63], v[204:207], v[184:187], v[48:63]
    ds_read_b64_tr_b16 v[178:179], v12 offset:1024
    v_add_f32 v209, v212, v208
    v_cos_f32 v215, v212
    buffer_load_dword v20, v16, s[20:23], s82 offen offset:0 sc1
    v_mfma_f32_32x32x16_bf16 v[64:79], v[200:203], v[188:191], v[64:79]
    ds_read_b64_tr_b16 v[180:181], v12 offset:16384
    v_sin_f32 v216, -v212
    v_cvt_pk_bf16_f32 v217, v213, v215
    v_mfma_f32_32x32x16_bf16 v[80:95], v[204:207], v[188:191], v[80:95]
    ds_read_b64_tr_b16 v[182:183], v12 offset:17408
    v_cvt_pk_bf16_f32 v218, v214, v216
    v_accvgpr_write_b32 a216, v217
    buffer_load_dword v21, v16, s[20:23], s82 offen offset:128 sc1
    v_mfma_f32_32x32x16_bf16 v[96:111], v[200:203], v[192:195], v[96:111]
    ds_read_b128 v[160:163], v8 offset:0
    v_cndmask_b32 v218, v218, v211, s[64:65]
    v_accvgpr_write_b32 a220, v218
    v_mfma_f32_32x32x16_bf16 v[112:127], v[204:207], v[192:195], v[112:127]
    ds_read_b128 v[164:167], v8 offset:4096
    v_add_f32 v212, v209, v208
    v_cos_f32 v213, v209
    buffer_load_dword v22, v16, s[20:23], s82 offen offset:256 sc1
    v_mfma_f32_32x32x16_bf16 v[128:143], v[200:203], v[196:199], v[128:143]
    ds_read_b128 v[168:171], v8 offset:8192
    v_sin_f32 v214, -v209
    v_add_f32 v209, v212, v208
    v_mfma_f32_32x32x16_bf16 v[144:159], v[204:207], v[196:199], v[144:159]
    ds_read_b128 v[172:175], v8 offset:12288
    v_cos_f32 v215, v212
    v_sin_f32 v216, -v212
    buffer_load_dword v23, v16, s[20:23], s82 offen offset:384 sc1
    s_waitcnt lgkmcnt(0)
    v_mfma_f32_32x32x16_bf16 v[32:47], v[176:179], v[160:163], v[32:47]
    ds_read_b64_tr_b16 v[200:201], v12 offset:4096
    v_cvt_pk_bf16_f32 v217, v213, v215
    v_cvt_pk_bf16_f32 v218, v214, v216
    v_mfma_f32_32x32x16_bf16 v[48:63], v[180:183], v[160:163], v[48:63]
    ds_read_b64_tr_b16 v[202:203], v12 offset:5120
    v_accvgpr_write_b32 a217, v217
    v_cndmask_b32 v218, v218, v211, s[64:65]
    buffer_load_dwordx4 v[224:227], v17, s[20:23], s83 offen offset:0 sc1
    v_mfma_f32_32x32x16_bf16 v[64:79], v[176:179], v[164:167], v[64:79]
    ds_read_b64_tr_b16 v[204:205], v12 offset:20480
    v_accvgpr_write_b32 a221, v218
    v_add_f32 v212, v209, v208
    v_mfma_f32_32x32x16_bf16 v[80:95], v[180:183], v[164:167], v[80:95]
    ds_read_b64_tr_b16 v[206:207], v12 offset:21504
    v_cos_f32 v213, v209
    v_sin_f32 v214, -v209
    buffer_load_dwordx4 v[228:231], v17, s[20:23], s83 offen offset:32 sc1
    v_mfma_f32_32x32x16_bf16 v[96:111], v[176:179], v[168:171], v[96:111]
    ds_read_b128 v[184:187], v9 offset:0
    v_add_f32 v209, v212, v208
    v_cos_f32 v215, v212
    v_mfma_f32_32x32x16_bf16 v[112:127], v[180:183], v[168:171], v[112:127]
    ds_read_b128 v[188:191], v9 offset:4096
    v_sin_f32 v216, -v212
    v_cvt_pk_bf16_f32 v217, v213, v215
    buffer_load_dwordx4 v[232:235], v17, s[20:23], s83 offen offset:64 sc1
    v_mfma_f32_32x32x16_bf16 v[128:143], v[176:179], v[172:175], v[128:143]
    ds_read_b128 v[192:195], v9 offset:8192
    v_cvt_pk_bf16_f32 v218, v214, v216
    v_accvgpr_write_b32 a218, v217
    v_mfma_f32_32x32x16_bf16 v[144:159], v[180:183], v[172:175], v[144:159]
    ds_read_b128 v[196:199], v9 offset:12288
    v_cndmask_b32 v218, v218, v211, s[64:65]
    v_accvgpr_write_b32 a222, v218
    buffer_load_dwordx4 v[236:239], v17, s[20:23], s83 offen offset:96 sc1
    s_waitcnt lgkmcnt(0)
    v_mfma_f32_32x32x16_bf16 v[32:47], v[200:203], v[184:187], v[32:47]
    ds_read_b64_tr_b16 v[176:177], v12 offset:8192
    v_add_f32 v212, v209, v208
    v_cos_f32 v213, v209
    v_mfma_f32_32x32x16_bf16 v[48:63], v[204:207], v[184:187], v[48:63]
    ds_read_b64_tr_b16 v[178:179], v12 offset:9216
    v_sin_f32 v214, -v209
    v_add_f32 v209, v212, v210
    buffer_load_dwordx4 v[240:243], v17, s[20:23], s83 offen offset:128 sc1
    v_mfma_f32_32x32x16_bf16 v[64:79], v[200:203], v[188:191], v[64:79]
    ds_read_b64_tr_b16 v[180:181], v12 offset:24576
    v_cos_f32 v215, v212
    v_sin_f32 v216, -v212
    v_mfma_f32_32x32x16_bf16 v[80:95], v[204:207], v[188:191], v[80:95]
    ds_read_b64_tr_b16 v[182:183], v12 offset:25600
    v_cvt_pk_bf16_f32 v217, v213, v215
    v_cvt_pk_bf16_f32 v218, v214, v216
    buffer_load_dwordx4 v[244:247], v17, s[20:23], s83 offen offset:160 sc1
    v_mfma_f32_32x32x16_bf16 v[96:111], v[200:203], v[192:195], v[96:111]
    ds_read_b128 v[160:163], v10 offset:0
    v_accvgpr_write_b32 a219, v217
    v_cndmask_b32 v218, v218, v211, s[64:65]
    v_mfma_f32_32x32x16_bf16 v[112:127], v[204:207], v[192:195], v[112:127]
    ds_read_b128 v[164:167], v10 offset:4096
    v_accvgpr_write_b32 a223, v218
    buffer_load_dwordx4 v[248:251], v17, s[20:23], s83 offen offset:192 sc1
    v_mfma_f32_32x32x16_bf16 v[128:143], v[200:203], v[196:199], v[128:143]
    ds_read_b128 v[168:171], v10 offset:8192
    v_mfma_f32_32x32x16_bf16 v[144:159], v[204:207], v[196:199], v[144:159]
    ds_read_b128 v[172:175], v10 offset:12288
    buffer_load_dwordx4 v[252:255], v17, s[20:23], s83 offen offset:224 sc1
    s_waitcnt lgkmcnt(0)
    v_mfma_f32_32x32x16_bf16 v[32:47], v[176:179], v[160:163], v[32:47]
    ds_read_b64_tr_b16 v[200:201], v12 offset:12288
    v_mfma_f32_32x32x16_bf16 v[48:63], v[180:183], v[160:163], v[48:63]
    ds_read_b64_tr_b16 v[202:203], v12 offset:13312
    buffer_load_dwordx4 a[0:3], v1, s[20:23], s81 offen offset:0 sc1
    v_mfma_f32_32x32x16_bf16 v[64:79], v[176:179], v[164:167], v[64:79]
    ds_read_b64_tr_b16 v[204:205], v12 offset:28672
    v_mfma_f32_32x32x16_bf16 v[80:95], v[180:183], v[164:167], v[80:95]
    ds_read_b64_tr_b16 v[206:207], v12 offset:29696
    buffer_load_dwordx4 a[4:7], v1, s[20:23], s81 offen offset:1024 sc1
    v_mfma_f32_32x32x16_bf16 v[96:111], v[176:179], v[168:171], v[96:111]
    ds_read_b128 v[184:187], v11 offset:0
    v_mfma_f32_32x32x16_bf16 v[112:127], v[180:183], v[168:171], v[112:127]
    ds_read_b128 v[188:191], v11 offset:4096
    buffer_load_dwordx4 a[8:11], v1, s[20:23], s81 offen offset:2048 sc1
    v_mfma_f32_32x32x16_bf16 v[128:143], v[176:179], v[172:175], v[128:143]
    ds_read_b128 v[192:195], v11 offset:8192
    v_mfma_f32_32x32x16_bf16 v[144:159], v[180:183], v[172:175], v[144:159]
    ds_read_b128 v[196:199], v11 offset:12288
    buffer_load_dwordx4 a[12:15], v1, s[20:23], s81 offen offset:3072 sc1
    s_add_u32 s81, s81, 4096
    s_cmp_ge_u32 s81, s47
    s_cselect_b32 s81, s46, s81
    s_waitcnt vmcnt(16) lgkmcnt(0)
    s_barrier
    v_mfma_f32_32x32x16_bf16 v[32:47], v[200:203], v[184:187], v[32:47]
    ds_read_b64_tr_b16 v[176:177], v12 offset:32768
    v_mfma_f32_32x32x16_bf16 v[48:63], v[204:207], v[184:187], v[48:63]
    ds_read_b64_tr_b16 v[178:179], v12 offset:33792
    buffer_load_dwordx4 a[16:19], v1, s[20:23], s81 offen offset:0 sc1
    v_mfma_f32_32x32x16_bf16 v[64:79], v[200:203], v[188:191], v[64:79]
    ds_read_b64_tr_b16 v[180:181], v12 offset:49152
    v_mfma_f32_32x32x16_bf16 v[80:95], v[204:207], v[188:191], v[80:95]
    ds_read_b64_tr_b16 v[182:183], v12 offset:50176
    buffer_load_dwordx4 a[20:23], v1, s[20:23], s81 offen offset:1024 sc1
    v_mfma_f32_32x32x16_bf16 v[96:111], v[200:203], v[192:195], v[96:111]
    ds_read_b128 v[160:163], v8 offset:16384
    v_mfma_f32_32x32x16_bf16 v[112:127], v[204:207], v[192:195], v[112:127]
    ds_read_b128 v[164:167], v8 offset:20480
    buffer_load_dwordx4 a[24:27], v1, s[20:23], s81 offen offset:2048 sc1
    v_mfma_f32_32x32x16_bf16 v[128:143], v[200:203], v[196:199], v[128:143]
    ds_read_b128 v[168:171], v8 offset:24576
    v_mfma_f32_32x32x16_bf16 v[144:159], v[204:207], v[196:199], v[144:159]
    ds_read_b128 v[172:175], v8 offset:28672
    buffer_load_dwordx4 a[28:31], v1, s[20:23], s81 offen offset:3072 sc1
    s_add_u32 s81, s81, 4096
    s_cmp_ge_u32 s81, s47
    s_cselect_b32 s81, s46, s81
    s_waitcnt lgkmcnt(0)
    v_mfma_f32_32x32x16_bf16 v[32:47], v[176:179], v[160:163], v[32:47]
    ds_read_b64_tr_b16 v[200:201], v12 offset:36864
    v_mfma_f32_32x32x16_bf16 v[48:63], v[180:183], v[160:163], v[48:63]
    ds_read_b64_tr_b16 v[202:203], v12 offset:37888
    buffer_load_dwordx4 a[32:35], v1, s[20:23], s81 offen offset:0 sc1
    v_mfma_f32_32x32x16_bf16 v[64:79], v[176:179], v[164:167], v[64:79]
    ds_read_b64_tr_b16 v[204:205], v12 offset:53248
    v_mfma_f32_32x32x16_bf16 v[80:95], v[180:183], v[164:167], v[80:95]
    ds_read_b64_tr_b16 v[206:207], v12 offset:54272
    buffer_load_dwordx4 a[36:39], v1, s[20:23], s81 offen offset:1024 sc1
    v_mfma_f32_32x32x16_bf16 v[96:111], v[176:179], v[168:171], v[96:111]
    ds_read_b128 v[184:187], v9 offset:16384
    v_mfma_f32_32x32x16_bf16 v[112:127], v[180:183], v[168:171], v[112:127]
    ds_read_b128 v[188:191], v9 offset:20480
    buffer_load_dwordx4 a[40:43], v1, s[20:23], s81 offen offset:2048 sc1
    v_mfma_f32_32x32x16_bf16 v[128:143], v[176:179], v[172:175], v[128:143]
    ds_read_b128 v[192:195], v9 offset:24576
    v_mfma_f32_32x32x16_bf16 v[144:159], v[180:183], v[172:175], v[144:159]
    ds_read_b128 v[196:199], v9 offset:28672
    buffer_load_dwordx4 a[44:47], v1, s[20:23], s81 offen offset:3072 sc1
    s_add_u32 s81, s81, 4096
    s_cmp_ge_u32 s81, s47
    s_cselect_b32 s81, s46, s81
    s_waitcnt lgkmcnt(0)
    v_mfma_f32_32x32x16_bf16 v[32:47], v[200:203], v[184:187], v[32:47]
    ds_read_b64_tr_b16 v[176:177], v12 offset:40960
    v_mfma_f32_32x32x16_bf16 v[48:63], v[204:207], v[184:187], v[48:63]
    ds_read_b64_tr_b16 v[178:179], v12 offset:41984
    buffer_load_dwordx4 a[48:51], v1, s[20:23], s81 offen offset:0 sc1
    v_mfma_f32_32x32x16_bf16 v[64:79], v[200:203], v[188:191], v[64:79]
    ds_read_b64_tr_b16 v[180:181], v12 offset:57344
    v_mfma_f32_32x32x16_bf16 v[80:95], v[204:207], v[188:191], v[80:95]
    ds_read_b64_tr_b16 v[182:183], v12 offset:58368
    buffer_load_dwordx4 a[52:55], v1, s[20:23], s81 offen offset:1024 sc1
    v_mfma_f32_32x32x16_bf16 v[96:111], v[200:203], v[192:195], v[96:111]
    ds_read_b128 v[160:163], v10 offset:16384
    v_mfma_f32_32x32x16_bf16 v[112:127], v[204:207], v[192:195], v[112:127]
    ds_read_b128 v[164:167], v10 offset:20480
    buffer_load_dwordx4 a[56:59], v1, s[20:23], s81 offen offset:2048 sc1
    v_mfma_f32_32x32x16_bf16 v[128:143], v[200:203], v[196:199], v[128:143]
    ds_read_b128 v[168:171], v10 offset:24576
    v_mfma_f32_32x32x16_bf16 v[144:159], v[204:207], v[196:199], v[144:159]
    ds_read_b128 v[172:175], v10 offset:28672
    buffer_load_dwordx4 a[60:63], v1, s[20:23], s81 offen offset:3072 sc1
    s_add_u32 s81, s81, 4096
    s_cmp_ge_u32 s81, s47
    s_cselect_b32 s81, s46, s81
    s_waitcnt lgkmcnt(0)
    v_mfma_f32_32x32x16_bf16 v[32:47], v[176:179], v[160:163], v[32:47]
    ds_read_b64_tr_b16 v[200:201], v12 offset:45056
    v_mfma_f32_32x32x16_bf16 v[48:63], v[180:183], v[160:163], v[48:63]
    ds_read_b64_tr_b16 v[202:203], v12 offset:46080
    buffer_load_dwordx4 a[64:67], v1, s[20:23], s81 offen offset:0 sc1
    v_mfma_f32_32x32x16_bf16 v[64:79], v[176:179], v[164:167], v[64:79]
    ds_read_b64_tr_b16 v[204:205], v12 offset:61440
    v_mfma_f32_32x32x16_bf16 v[80:95], v[180:183], v[164:167], v[80:95]
    ds_read_b64_tr_b16 v[206:207], v12 offset:62464
    buffer_load_dwordx4 a[68:71], v1, s[20:23], s81 offen offset:1024 sc1
    v_mfma_f32_32x32x16_bf16 v[96:111], v[176:179], v[168:171], v[96:111]
    ds_read_b128 v[184:187], v11 offset:16384
    v_mfma_f32_32x32x16_bf16 v[112:127], v[180:183], v[168:171], v[112:127]
    ds_read_b128 v[188:191], v11 offset:20480
    buffer_load_dwordx4 a[72:75], v1, s[20:23], s81 offen offset:2048 sc1
    v_mfma_f32_32x32x16_bf16 v[128:143], v[176:179], v[172:175], v[128:143]
    ds_read_b128 v[192:195], v11 offset:24576
    v_mfma_f32_32x32x16_bf16 v[144:159], v[180:183], v[172:175], v[144:159]
    ds_read_b128 v[196:199], v11 offset:28672
    buffer_load_dwordx4 a[76:79], v1, s[20:23], s81 offen offset:3072 sc1
    s_add_u32 s81, s81, 4096
    s_cmp_ge_u32 s81, s47
    s_cselect_b32 s81, s46, s81
    s_waitcnt lgkmcnt(0)
    v_mfma_f32_32x32x16_bf16 v[32:47], v[200:203], v[184:187], v[32:47]
    v_mfma_f32_32x32x16_bf16 v[48:63], v[204:207], v[184:187], v[48:63]
    buffer_load_dwordx4 a[80:83], v1, s[20:23], s81 offen offset:0 sc1
    v_mfma_f32_32x32x16_bf16 v[64:79], v[200:203], v[188:191], v[64:79]
    v_mfma_f32_32x32x16_bf16 v[80:95], v[204:207], v[188:191], v[80:95]
    buffer_load_dwordx4 a[84:87], v1, s[20:23], s81 offen offset:1024 sc1
    v_mfma_f32_32x32x16_bf16 v[96:111], v[200:203], v[192:195], v[96:111]
    v_mfma_f32_32x32x16_bf16 v[112:127], v[204:207], v[192:195], v[112:127]
    buffer_load_dwordx4 a[88:91], v1, s[20:23], s81 offen offset:2048 sc1
    v_mfma_f32_32x32x16_bf16 v[128:143], v[200:203], v[196:199], v[128:143]
    v_mfma_f32_32x32x16_bf16 v[144:159], v[204:207], v[196:199], v[144:159]
    buffer_load_dwordx4 a[92:95], v1, s[20:23], s81 offen offset:3072 sc1
    s_add_u32 s81, s81, 4096
    s_cmp_ge_u32 s81, s47
    s_cselect_b32 s81, s46, s81
    buffer_load_dwordx4 a[96:99], v1, s[20:23], s81 offen offset:0 sc1
    buffer_load_dwordx4 a[100:103], v1, s[20:23], s81 offen offset:1024 sc1
    buffer_load_dwordx4 a[104:107], v1, s[20:23], s81 offen offset:2048 sc1
    buffer_load_dwordx4 a[108:111], v1, s[20:23], s81 offen offset:3072 sc1
    s_add_u32 s81, s81, 4096
    s_cmp_ge_u32 s81, s47
    s_cselect_b32 s81, s46, s81
    buffer_load_dwordx4 a[112:115], v1, s[20:23], s81 offen offset:0 sc1
    buffer_load_dwordx4 a[116:119], v1, s[20:23], s81 offen offset:1024 sc1
    buffer_load_dwordx4 a[120:123], v1, s[20:23], s81 offen offset:2048 sc1
    buffer_load_dwordx4 a[124:127], v1, s[20:23], s81 offen offset:3072 sc1
    s_add_u32 s81, s81, 4096
    s_cmp_ge_u32 s81, s47
    s_cselect_b32 s81, s46, s81
    s_mul_i32 s36, s6, 224
    s_lshl_b32 s38, s7, 3
    s_add_u32 s36, s36, s38
    s_lshl_b32 s38, s3, 1
    s_add_u32 s36, s36, s38
    s_lshl_b32 s36, s36, 11
    s_add_u32 s38, s36, 229376
    s_waitcnt vmcnt(32)
    v_sub_f32 v20, 1.0, v20
    v_sub_f32 v21, 1.0, v21
    v_sub_f32 v22, 1.0, v22
    v_sub_f32 v23, 1.0, v23
    v_rcp_f32 v20, v20
    v_rcp_f32 v21, v21
    v_rcp_f32 v22, v22
    v_rcp_f32 v23, v23
    s_mov_b32 s64, 0xbfb8aa3b
    s_mov_b32 s65, 0xbfb8aa3b
    v_min_f32 v24, 0x71800000, v20
    v_min_f32 v25, 0x71800000, v20
    v_min_f32 v26, 0x71800000, v21
    v_min_f32 v27, 0x71800000, v21
    v_min_f32 v28, 0x71800000, v22
    v_min_f32 v29, 0x71800000, v22
    v_min_f32 v30, 0x71800000, v23
    v_min_f32 v31, 0x71800000, v23
    v_pk_mul_f32 v[160:161], v[32:33], s[64:65]
    v_pk_mul_f32 v[162:163], v[34:35], s[64:65]
    v_pk_mul_f32 v[164:165], v[36:37], s[64:65]
    v_pk_mul_f32 v[166:167], v[38:39], s[64:65]
    v_exp_f32 v160, v160
    v_exp_f32 v161, v161
    v_exp_f32 v162, v162
    v_exp_f32 v163, v163
    v_exp_f32 v164, v164
    v_exp_f32 v165, v165
    v_exp_f32 v166, v166
    v_exp_f32 v167, v167
    v_pk_mul_f32 v[32:33], v[32:33], v[48:49]
    v_pk_mul_f32 v[34:35], v[34:35], v[50:51]
    v_pk_mul_f32 v[36:37], v[36:37], v[52:53]
    v_pk_mul_f32 v[38:39], v[38:39], v[54:55]
    v_pk_fma_f32 v[160:161], v[160:161], v[24:25], v[24:25]
    v_pk_fma_f32 v[162:163], v[162:163], v[24:25], v[24:25]
    v_pk_fma_f32 v[164:165], v[164:165], v[24:25], v[24:25]
    v_pk_fma_f32 v[166:167], v[166:167], v[24:25], v[24:25]
    v_rcp_f32 v160, v160
    v_rcp_f32 v161, v161
    v_rcp_f32 v162, v162
    v_rcp_f32 v163, v163
    v_rcp_f32 v164, v164
    v_rcp_f32 v165, v165
    v_rcp_f32 v166, v166
    v_rcp_f32 v167, v167
    v_pk_mul_f32 v[32:33], v[32:33], v[160:161]
    v_pk_mul_f32 v[34:35], v[34:35], v[162:163]
    v_pk_mul_f32 v[36:37], v[36:37], v[164:165]
    v_pk_mul_f32 v[38:39], v[38:39], v[166:167]
    v_cvt_pk_bf16_f32 v48, v32, v33
    v_cvt_pk_bf16_f32 v49, v34, v35
    v_cvt_pk_bf16_f32 v50, v36, v37
    v_cvt_pk_bf16_f32 v51, v38, v39
    buffer_store_dwordx4 v[48:51], v1, s[20:23], s36 offen offset:0 sc1
    v_pk_mul_f32 v[160:161], v[40:41], s[64:65]
    v_pk_mul_f32 v[162:163], v[42:43], s[64:65]
    v_pk_mul_f32 v[164:165], v[44:45], s[64:65]
    v_pk_mul_f32 v[166:167], v[46:47], s[64:65]
    v_exp_f32 v160, v160
    v_exp_f32 v161, v161
    v_exp_f32 v162, v162
    v_exp_f32 v163, v163
    v_exp_f32 v164, v164
    v_exp_f32 v165, v165
    v_exp_f32 v166, v166
    v_exp_f32 v167, v167
    v_pk_mul_f32 v[40:41], v[40:41], v[56:57]
    v_pk_mul_f32 v[42:43], v[42:43], v[58:59]
    v_pk_mul_f32 v[44:45], v[44:45], v[60:61]
    v_pk_mul_f32 v[46:47], v[46:47], v[62:63]
    v_pk_fma_f32 v[160:161], v[160:161], v[24:25], v[24:25]
    v_pk_fma_f32 v[162:163], v[162:163], v[24:25], v[24:25]
    v_pk_fma_f32 v[164:165], v[164:165], v[24:25], v[24:25]
    v_pk_fma_f32 v[166:167], v[166:167], v[24:25], v[24:25]
    v_rcp_f32 v160, v160
    v_rcp_f32 v161, v161
    v_rcp_f32 v162, v162
    v_rcp_f32 v163, v163
    v_rcp_f32 v164, v164
    v_rcp_f32 v165, v165
    v_rcp_f32 v166, v166
    v_rcp_f32 v167, v167
    v_pk_mul_f32 v[40:41], v[40:41], v[160:161]
    v_pk_mul_f32 v[42:43], v[42:43], v[162:163]
    v_pk_mul_f32 v[44:45], v[44:45], v[164:165]
    v_pk_mul_f32 v[46:47], v[46:47], v[166:167]
    v_cvt_pk_bf16_f32 v56, v40, v41
    v_cvt_pk_bf16_f32 v57, v42, v43
    v_cvt_pk_bf16_f32 v58, v44, v45
    v_cvt_pk_bf16_f32 v59, v46, v47
    buffer_store_dwordx4 v[56:59], v1, s[20:23], s36 offen offset:2048 sc1
    v_pk_mul_f32 v[160:161], v[64:65], s[64:65]
    v_pk_mul_f32 v[162:163], v[66:67], s[64:65]
    v_pk_mul_f32 v[164:165], v[68:69], s[64:65]
    v_pk_mul_f32 v[166:167], v[70:71], s[64:65]
    v_exp_f32 v160, v160
    v_exp_f32 v161, v161
    v_exp_f32 v162, v162
    v_exp_f32 v163, v163
    v_exp_f32 v164, v164
    v_exp_f32 v165, v165
    v_exp_f32 v166, v166
    v_exp_f32 v167, v167
    v_pk_mul_f32 v[64:65], v[64:65], v[80:81]
    v_pk_mul_f32 v[66:67], v[66:67], v[82:83]
    v_pk_mul_f32 v[68:69], v[68:69], v[84:85]
    v_pk_mul_f32 v[70:71], v[70:71], v[86:87]
    v_pk_fma_f32 v[160:161], v[160:161], v[26:27], v[26:27]
    v_pk_fma_f32 v[162:163], v[162:163], v[26:27], v[26:27]
    v_pk_fma_f32 v[164:165], v[164:165], v[26:27], v[26:27]
    v_pk_fma_f32 v[166:167], v[166:167], v[26:27], v[26:27]
    v_rcp_f32 v160, v160
    v_rcp_f32 v161, v161
    v_rcp_f32 v162, v162
    v_rcp_f32 v163, v163
    v_rcp_f32 v164, v164
    v_rcp_f32 v165, v165
    v_rcp_f32 v166, v166
    v_rcp_f32 v167, v167
    v_pk_mul_f32 v[64:65], v[64:65], v[160:161]
    v_pk_mul_f32 v[66:67], v[66:67], v[162:163]
    v_pk_mul_f32 v[68:69], v[68:69], v[164:165]
    v_pk_mul_f32 v[70:71], v[70:71], v[166:167]
    v_cvt_pk_bf16_f32 v80, v64, v65
    v_cvt_pk_bf16_f32 v81, v66, v67
    v_cvt_pk_bf16_f32 v82, v68, v69
    v_cvt_pk_bf16_f32 v83, v70, v71
    buffer_store_dwordx4 v[80:83], v1, s[20:23], s36 offen offset:1024 sc1
    v_pk_mul_f32 v[160:161], v[72:73], s[64:65]
    v_pk_mul_f32 v[162:163], v[74:75], s[64:65]
    v_pk_mul_f32 v[164:165], v[76:77], s[64:65]
    v_pk_mul_f32 v[166:167], v[78:79], s[64:65]
    v_exp_f32 v160, v160
    v_exp_f32 v161, v161
    v_exp_f32 v162, v162
    v_exp_f32 v163, v163
    v_exp_f32 v164, v164
    v_exp_f32 v165, v165
    v_exp_f32 v166, v166
    v_exp_f32 v167, v167
    v_pk_mul_f32 v[72:73], v[72:73], v[88:89]
    v_pk_mul_f32 v[74:75], v[74:75], v[90:91]
    v_pk_mul_f32 v[76:77], v[76:77], v[92:93]
    v_pk_mul_f32 v[78:79], v[78:79], v[94:95]
    v_pk_fma_f32 v[160:161], v[160:161], v[26:27], v[26:27]
    v_pk_fma_f32 v[162:163], v[162:163], v[26:27], v[26:27]
    v_pk_fma_f32 v[164:165], v[164:165], v[26:27], v[26:27]
    v_pk_fma_f32 v[166:167], v[166:167], v[26:27], v[26:27]
    v_rcp_f32 v160, v160
    v_rcp_f32 v161, v161
    v_rcp_f32 v162, v162
    v_rcp_f32 v163, v163
    v_rcp_f32 v164, v164
    v_rcp_f32 v165, v165
    v_rcp_f32 v166, v166
    v_rcp_f32 v167, v167
    v_pk_mul_f32 v[72:73], v[72:73], v[160:161]
    v_pk_mul_f32 v[74:75], v[74:75], v[162:163]
    v_pk_mul_f32 v[76:77], v[76:77], v[164:165]
    v_pk_mul_f32 v[78:79], v[78:79], v[166:167]
    v_cvt_pk_bf16_f32 v88, v72, v73
    v_cvt_pk_bf16_f32 v89, v74, v75
    v_cvt_pk_bf16_f32 v90, v76, v77
    v_cvt_pk_bf16_f32 v91, v78, v79
    buffer_store_dwordx4 v[88:91], v1, s[20:23], s36 offen offset:3072 sc1
    v_pk_mul_f32 v[160:161], v[96:97], s[64:65]
    v_pk_mul_f32 v[162:163], v[98:99], s[64:65]
    v_pk_mul_f32 v[164:165], v[100:101], s[64:65]
    v_pk_mul_f32 v[166:167], v[102:103], s[64:65]
    v_exp_f32 v160, v160
    v_exp_f32 v161, v161
    v_exp_f32 v162, v162
    v_exp_f32 v163, v163
    v_exp_f32 v164, v164
    v_exp_f32 v165, v165
    v_exp_f32 v166, v166
    v_exp_f32 v167, v167
    v_pk_mul_f32 v[96:97], v[96:97], v[112:113]
    v_pk_mul_f32 v[98:99], v[98:99], v[114:115]
    v_pk_mul_f32 v[100:101], v[100:101], v[116:117]
    v_pk_mul_f32 v[102:103], v[102:103], v[118:119]
    v_pk_fma_f32 v[160:161], v[160:161], v[28:29], v[28:29]
    v_pk_fma_f32 v[162:163], v[162:163], v[28:29], v[28:29]
    v_pk_fma_f32 v[164:165], v[164:165], v[28:29], v[28:29]
    v_pk_fma_f32 v[166:167], v[166:167], v[28:29], v[28:29]
    v_rcp_f32 v160, v160
    v_rcp_f32 v161, v161
    v_rcp_f32 v162, v162
    v_rcp_f32 v163, v163
    v_rcp_f32 v164, v164
    v_rcp_f32 v165, v165
    v_rcp_f32 v166, v166
    v_rcp_f32 v167, v167
    v_pk_mul_f32 v[96:97], v[96:97], v[160:161]
    v_pk_mul_f32 v[98:99], v[98:99], v[162:163]
    v_pk_mul_f32 v[100:101], v[100:101], v[164:165]
    v_pk_mul_f32 v[102:103], v[102:103], v[166:167]
    v_cvt_pk_bf16_f32 v112, v96, v97
    v_cvt_pk_bf16_f32 v113, v98, v99
    v_cvt_pk_bf16_f32 v114, v100, v101
    v_cvt_pk_bf16_f32 v115, v102, v103
    buffer_store_dwordx4 v[112:115], v1, s[20:23], s38 offen offset:0 sc1
    v_pk_mul_f32 v[160:161], v[104:105], s[64:65]
    v_pk_mul_f32 v[162:163], v[106:107], s[64:65]
    v_pk_mul_f32 v[164:165], v[108:109], s[64:65]
    v_pk_mul_f32 v[166:167], v[110:111], s[64:65]
    v_exp_f32 v160, v160
    v_exp_f32 v161, v161
    v_exp_f32 v162, v162
    v_exp_f32 v163, v163
    v_exp_f32 v164, v164
    v_exp_f32 v165, v165
    v_exp_f32 v166, v166
    v_exp_f32 v167, v167
    v_pk_mul_f32 v[104:105], v[104:105], v[120:121]
    v_pk_mul_f32 v[106:107], v[106:107], v[122:123]
    v_pk_mul_f32 v[108:109], v[108:109], v[124:125]
    v_pk_mul_f32 v[110:111], v[110:111], v[126:127]
    v_pk_fma_f32 v[160:161], v[160:161], v[28:29], v[28:29]
    v_pk_fma_f32 v[162:163], v[162:163], v[28:29], v[28:29]
    v_pk_fma_f32 v[164:165], v[164:165], v[28:29], v[28:29]
    v_pk_fma_f32 v[166:167], v[166:167], v[28:29], v[28:29]
    v_rcp_f32 v160, v160
    v_rcp_f32 v161, v161
    v_rcp_f32 v162, v162
    v_rcp_f32 v163, v163
    v_rcp_f32 v164, v164
    v_rcp_f32 v165, v165
    v_rcp_f32 v166, v166
    v_rcp_f32 v167, v167
    v_pk_mul_f32 v[104:105], v[104:105], v[160:161]
    v_pk_mul_f32 v[106:107], v[106:107], v[162:163]
    v_pk_mul_f32 v[108:109], v[108:109], v[164:165]
    v_pk_mul_f32 v[110:111], v[110:111], v[166:167]
    v_cvt_pk_bf16_f32 v120, v104, v105
    v_cvt_pk_bf16_f32 v121, v106, v107
    v_cvt_pk_bf16_f32 v122, v108, v109
    v_cvt_pk_bf16_f32 v123, v110, v111
    buffer_store_dwordx4 v[120:123], v1, s[20:23], s38 offen offset:2048 sc1
    v_pk_mul_f32 v[160:161], v[128:129], s[64:65]
    v_pk_mul_f32 v[162:163], v[130:131], s[64:65]
    v_pk_mul_f32 v[164:165], v[132:133], s[64:65]
    v_pk_mul_f32 v[166:167], v[134:135], s[64:65]
    v_exp_f32 v160, v160
    v_exp_f32 v161, v161
    v_exp_f32 v162, v162
    v_exp_f32 v163, v163
    v_exp_f32 v164, v164
    v_exp_f32 v165, v165
    v_exp_f32 v166, v166
    v_exp_f32 v167, v167
    v_pk_mul_f32 v[128:129], v[128:129], v[144:145]
    v_pk_mul_f32 v[130:131], v[130:131], v[146:147]
    v_pk_mul_f32 v[132:133], v[132:133], v[148:149]
    v_pk_mul_f32 v[134:135], v[134:135], v[150:151]
    v_pk_fma_f32 v[160:161], v[160:161], v[30:31], v[30:31]
    v_pk_fma_f32 v[162:163], v[162:163], v[30:31], v[30:31]
    v_pk_fma_f32 v[164:165], v[164:165], v[30:31], v[30:31]
    v_pk_fma_f32 v[166:167], v[166:167], v[30:31], v[30:31]
    v_rcp_f32 v160, v160
    v_rcp_f32 v161, v161
    v_rcp_f32 v162, v162
    v_rcp_f32 v163, v163
    v_rcp_f32 v164, v164
    v_rcp_f32 v165, v165
    v_rcp_f32 v166, v166
    v_rcp_f32 v167, v167
    v_pk_mul_f32 v[128:129], v[128:129], v[160:161]
    v_pk_mul_f32 v[130:131], v[130:131], v[162:163]
    v_pk_mul_f32 v[132:133], v[132:133], v[164:165]
    v_pk_mul_f32 v[134:135], v[134:135], v[166:167]
    v_cvt_pk_bf16_f32 v144, v128, v129
    v_cvt_pk_bf16_f32 v145, v130, v131
    v_cvt_pk_bf16_f32 v146, v132, v133
    v_cvt_pk_bf16_f32 v147, v134, v135
    buffer_store_dwordx4 v[144:147], v1, s[20:23], s38 offen offset:1024 sc1
    v_pk_mul_f32 v[160:161], v[136:137], s[64:65]
    v_pk_mul_f32 v[162:163], v[138:139], s[64:65]
    v_pk_mul_f32 v[164:165], v[140:141], s[64:65]
    v_pk_mul_f32 v[166:167], v[142:143], s[64:65]
    v_exp_f32 v160, v160
    v_exp_f32 v161, v161
    v_exp_f32 v162, v162
    v_exp_f32 v163, v163
    v_exp_f32 v164, v164
    v_exp_f32 v165, v165
    v_exp_f32 v166, v166
    v_exp_f32 v167, v167
    v_pk_mul_f32 v[136:137], v[136:137], v[152:153]
    v_pk_mul_f32 v[138:139], v[138:139], v[154:155]
    v_pk_mul_f32 v[140:141], v[140:141], v[156:157]
    v_pk_mul_f32 v[142:143], v[142:143], v[158:159]
    v_pk_fma_f32 v[160:161], v[160:161], v[30:31], v[30:31]
    v_pk_fma_f32 v[162:163], v[162:163], v[30:31], v[30:31]
    v_pk_fma_f32 v[164:165], v[164:165], v[30:31], v[30:31]
    v_pk_fma_f32 v[166:167], v[166:167], v[30:31], v[30:31]
    v_rcp_f32 v160, v160
    v_rcp_f32 v161, v161
    v_rcp_f32 v162, v162
    v_rcp_f32 v163, v163
    v_rcp_f32 v164, v164
    v_rcp_f32 v165, v165
    v_rcp_f32 v166, v166
    v_rcp_f32 v167, v167
    v_pk_mul_f32 v[136:137], v[136:137], v[160:161]
    v_pk_mul_f32 v[138:139], v[138:139], v[162:163]
    v_pk_mul_f32 v[140:141], v[140:141], v[164:165]
    v_pk_mul_f32 v[142:143], v[142:143], v[166:167]
    v_cvt_pk_bf16_f32 v152, v136, v137
    v_cvt_pk_bf16_f32 v153, v138, v139
    v_cvt_pk_bf16_f32 v154, v140, v141
    v_cvt_pk_bf16_f32 v155, v142, v143
    buffer_store_dwordx4 v[152:155], v1, s[20:23], s38 offen offset:3072 sc1
P1_DONE:
    s_waitcnt vmcnt(0)
    s_barrier
    v_mov_b32 v11, 1
    v_lshlrev_b32 v12, 8, v0
    s_cmp_eq_u32 s3, 0
    s_cselect_b64 exec, s[68:69], 0
    s_cbranch_execz NOFLAG
    buffer_store_dword v11, v12, s[20:23], s77 offen sc1
NOFLAG:
    s_mov_b64 exec, -1
    v_min_u32 v13, 45, v0
    v_lshlrev_b32 v13, 2, v13
    s_lshr_b32 s38, s78, 1
    s_lshl_b32 s38, s38, 8
    s_add_u32 s38, s38, 10264576
    s_mov_b32 s36, 0
    buffer_load_dwordx4 a[128:131], v1, s[20:23], s81 offen offset:0 sc1
    buffer_load_dwordx4 a[132:135], v1, s[20:23], s81 offen offset:1024 sc1
    buffer_load_dwordx4 a[136:139], v1, s[20:23], s81 offen offset:2048 sc1
    buffer_load_dwordx4 a[140:143], v1, s[20:23], s81 offen offset:3072 sc1
    s_add_u32 s81, s81, 4096
    s_cmp_ge_u32 s81, s47
    s_cselect_b32 s81, s46, s81
    buffer_load_dwordx4 a[144:147], v1, s[20:23], s81 offen offset:0 sc1
    buffer_load_dwordx4 a[148:151], v1, s[20:23], s81 offen offset:1024 sc1
    buffer_load_dwordx4 a[224:227], v1, s[20:23], s81 offen offset:2048 sc1
    buffer_load_dwordx4 a[228:231], v1, s[20:23], s81 offen offset:3072 sc1
    s_add_u32 s81, s81, 4096
    s_cmp_ge_u32 s81, s47
    s_cselect_b32 s81, s46, s81
    buffer_load_dwordx4 a[232:235], v1, s[20:23], s81 offen offset:0 sc1
    buffer_load_dwordx4 a[236:239], v1, s[20:23], s81 offen offset:1024 sc1
    buffer_load_dwordx4 a[240:243], v1, s[20:23], s81 offen offset:2048 sc1
    buffer_load_dwordx4 a[244:247], v1, s[20:23], s81 offen offset:3072 sc1
    s_add_u32 s81, s81, 4096
    s_cmp_ge_u32 s81, s47
    s_cselect_b32 s81, s46, s81
    s_cmp_eq_u32 s3, 0
    s_cbranch_scc0 NOEP
    buffer_load_dword v14, v13, s[20:23], s38 offen sc1
NOEP:
    buffer_load_dwordx4 a[248:251], v1, s[20:23], s81 offen offset:0 sc1
    buffer_load_dwordx4 a[252:255], v1, s[20:23], s81 offen offset:1024 sc1
    buffer_load_dwordx4 v[168:171], v1, s[20:23], s81 offen offset:2048 sc1
    buffer_load_dwordx4 v[172:175], v1, s[20:23], s81 offen offset:3072 sc1
    s_add_u32 s81, s81, 4096
    s_cmp_ge_u32 s81, s47
    s_cselect_b32 s81, s46, s81
    buffer_load_dwordx4 v[176:179], v1, s[20:23], s81 offen offset:0 sc1
    buffer_load_dwordx4 v[180:183], v1, s[20:23], s81 offen offset:1024 sc1
    buffer_load_dwordx4 v[184:187], v1, s[20:23], s81 offen offset:2048 sc1
    buffer_load_dwordx4 v[188:191], v1, s[20:23], s81 offen offset:3072 sc1
    s_add_u32 s81, s81, 4096
    s_cmp_ge_u32 s81, s47
    s_cselect_b32 s81, s46, s81
    buffer_load_dwordx4 v[192:195], v1, s[20:23], s81 offen offset:0 sc1
    buffer_load_dwordx4 v[196:199], v1, s[20:23], s81 offen offset:1024 sc1
    buffer_load_dwordx4 v[200:203], v1, s[20:23], s81 offen offset:2048 sc1
    buffer_load_dwordx4 v[204:207], v1, s[20:23], s81 offen offset:3072 sc1
    s_add_u32 s81, s81, 4096
    s_cmp_ge_u32 s81, s47
    s_cselect_b32 s81, s46, s81
    s_and_b32 s82, s78, 1
    s_lshl_b32 s82, s82, 3
    s_add_u32 s82, s82, s79
    s_mul_i32 s82, s82, 33
    s_lshl_b32 s39, s3, 3
    s_add_u32 s82, s82, s39
    s_lshl_b32 s82, s82, 11
    s_add_u32 s82, s82, 9175040
    s_cmp_eq_u32 s3, 3
    s_cselect_b32 s39, 0, 0x40000000
    s_cmp_eq_u32 s3, 0
    s_cbranch_scc0 POLLOK
    s_waitcnt vmcnt(12)
    v_cmp_ne_u32 vcc, 1, v14
    s_cbranch_vccz POLLOK
POLL:
    buffer_load_dword v14, v13, s[20:23], s38 offen sc1
    s_add_u32 s36, s36, 1
    s_waitcnt vmcnt(0)
    v_cmp_ne_u32 vcc, 1, v14
    s_cbranch_vccz POLLOK
    s_sleep 8
    s_cmp_lt_u32 s36, 0x40000
    s_cbranch_scc1 POLL
POLLOK:
    s_barrier
    buffer_load_dwordx4 v[96:99], v1, s[20:23], s82 offen offset:0 sc1
    buffer_load_dwordx4 v[100:103], v1, s[20:23], s82 offen offset:1024 sc1
    buffer_load_dwordx4 v[104:107], v1, s[20:23], s82 offen offset:2048 sc1
    buffer_load_dwordx4 v[108:111], v1, s[20:23], s82 offen offset:3072 sc1
    s_add_u32 s82, s82, 4096
    buffer_load_dwordx4 v[112:115], v1, s[20:23], s82 offen offset:0 sc1
    buffer_load_dwordx4 v[116:119], v1, s[20:23], s82 offen offset:1024 sc1
    buffer_load_dwordx4 v[120:123], v1, s[20:23], s82 offen offset:2048 sc1
    buffer_load_dwordx4 v[124:127], v1, s[20:23], s82 offen offset:3072 sc1
    s_add_u32 s82, s82, 4096
    buffer_load_dwordx4 v[128:131], v1, s[20:23], s82 offen offset:0 sc1
    buffer_load_dwordx4 v[132:135], v1, s[20:23], s82 offen offset:1024 sc1
    buffer_load_dwordx4 v[136:139], v1, s[20:23], s82 offen offset:2048 sc1
    buffer_load_dwordx4 v[140:143], v1, s[20:23], s82 offen offset:3072 sc1
    s_add_u32 s82, s82, 4096
    buffer_load_dwordx4 v[144:147], v1, s[20:23], s82 offen offset:0 sc1
    buffer_load_dwordx4 v[148:151], v1, s[20:23], s82 offen offset:1024 sc1
    buffer_load_dwordx4 v[152:155], v1, s[20:23], s82 offen offset:2048 sc1
    buffer_load_dwordx4 v[156:159], v1, s[20:23], s82 offen offset:3072 sc1
    s_add_u32 s82, s82, 4096
    s_add_u32 s82, s82, s39
    buffer_load_dwordx4 v[160:163], v1, s[20:23], s82 offen offset:0 sc1
    buffer_load_dwordx4 v[164:167], v1, s[20:23], s82 offen offset:1024 sc1
    buffer_load_dwordx4 v[208:211], v1, s[20:23], s80 offen offset:0 sc1
    buffer_load_dwordx4 v[212:215], v1, s[20:23], s80 offen offset:1024 sc1
    buffer_load_dwordx4 v[216:219], v1, s[20:23], s80 offen offset:2048 sc1
    buffer_load_dwordx4 v[220:223], v1, s[20:23], s80 offen offset:3072 sc1
    s_add_u32 s80, s80, 4096
    s_cmp_ge_u32 s80, s45
    s_cselect_b32 s80, s44, s80
    buffer_load_dwordx4 v[16:19], v1, s[20:23], s80 offen offset:0 sc1
    buffer_load_dwordx4 v[20:23], v1, s[20:23], s80 offen offset:1024 sc1
    buffer_load_dwordx4 v[24:27], v1, s[20:23], s80 offen offset:2048 sc1
    buffer_load_dwordx4 v[28:31], v1, s[20:23], s80 offen offset:3072 sc1
    s_add_u32 s80, s80, 4096
    s_cmp_ge_u32 s80, s45
    s_cselect_b32 s80, s44, s80
    s_waitcnt vmcnt(24)
    v_mfma_f32_32x32x16_bf16 v[32:47], a[152:155], v[96:99], 0
    v_mfma_f32_32x32x16_bf16 v[48:63], a[152:155], v[100:103], 0
    v_mfma_f32_32x32x16_bf16 v[64:79], a[156:159], v[96:99], 0
    v_mfma_f32_32x32x16_bf16 v[80:95], a[156:159], v[100:103], 0
    buffer_load_dwordx4 a[152:155], v1, s[20:23], s80 offen offset:0 sc1
    buffer_load_dwordx4 a[156:159], v1, s[20:23], s80 offen offset:1024 sc1
    s_waitcnt vmcnt(24)
    v_mfma_f32_32x32x16_bf16 v[32:47], a[160:163], v[104:107], v[32:47]
    v_mfma_f32_32x32x16_bf16 v[48:63], a[160:163], v[108:111], v[48:63]
    v_mfma_f32_32x32x16_bf16 v[64:79], a[164:167], v[104:107], v[64:79]
    v_mfma_f32_32x32x16_bf16 v[80:95], a[164:167], v[108:111], v[80:95]
    buffer_load_dwordx4 a[160:163], v1, s[20:23], s80 offen offset:2048 sc1
    buffer_load_dwordx4 a[164:167], v1, s[20:23], s80 offen offset:3072 sc1
    s_add_u32 s80, s80, 4096
    s_cmp_ge_u32 s80, s45
    s_cselect_b32 s80, s44, s80
    s_waitcnt vmcnt(24)
    v_mfma_f32_32x32x16_bf16 v[32:47], a[168:171], v[112:115], v[32:47]
    v_mfma_f32_32x32x16_bf16 v[48:63], a[168:171], v[116:119], v[48:63]
    v_mfma_f32_32x32x16_bf16 v[64:79], a[172:175], v[112:115], v[64:79]
    v_mfma_f32_32x32x16_bf16 v[80:95], a[172:175], v[116:119], v[80:95]
    buffer_load_dwordx4 a[168:171], v1, s[20:23], s80 offen offset:0 sc1
    buffer_load_dwordx4 a[172:175], v1, s[20:23], s80 offen offset:1024 sc1
    s_waitcnt vmcnt(24)
    v_mfma_f32_32x32x16_bf16 v[32:47], a[176:179], v[120:123], v[32:47]
    v_mfma_f32_32x32x16_bf16 v[48:63], a[176:179], v[124:127], v[48:63]
    v_mfma_f32_32x32x16_bf16 v[64:79], a[180:183], v[120:123], v[64:79]
    v_mfma_f32_32x32x16_bf16 v[80:95], a[180:183], v[124:127], v[80:95]
    buffer_load_dwordx4 a[176:179], v1, s[20:23], s80 offen offset:2048 sc1
    buffer_load_dwordx4 a[180:183], v1, s[20:23], s80 offen offset:3072 sc1
    s_add_u32 s80, s80, 4096
    s_cmp_ge_u32 s80, s45
    s_cselect_b32 s80, s44, s80
    s_waitcnt vmcnt(24)
    v_mfma_f32_32x32x16_bf16 v[32:47], a[184:187], v[128:131], v[32:47]
    v_mfma_f32_32x32x16_bf16 v[48:63], a[184:187], v[132:135], v[48:63]
    v_mfma_f32_32x32x16_bf16 v[64:79], a[188:191], v[128:131], v[64:79]
    v_mfma_f32_32x32x16_bf16 v[80:95], a[188:191], v[132:135], v[80:95]
    buffer_load_dwordx4 a[184:187], v1, s[20:23], s80 offen offset:0 sc1
    buffer_load_dwordx4 a[188:191], v1, s[20:23], s80 offen offset:1024 sc1
    s_waitcnt vmcnt(24)
    v_mfma_f32_32x32x16_bf16 v[32:47], a[192:195], v[136:139], v[32:47]
    v_mfma_f32_32x32x16_bf16 v[48:63], a[192:195], v[140:143], v[48:63]
    v_mfma_f32_32x32x16_bf16 v[64:79], a[196:199], v[136:139], v[64:79]
    v_mfma_f32_32x32x16_bf16 v[80:95], a[196:199], v[140:143], v[80:95]
    buffer_load_dwordx4 a[192:195], v1, s[20:23], s80 offen offset:2048 sc1
    buffer_load_dwordx4 a[196:199], v1, s[20:23], s80 offen offset:3072 sc1
    s_add_u32 s80, s80, 4096
    s_cmp_ge_u32 s80, s45
    s_cselect_b32 s80, s44, s80
    s_waitcnt vmcnt(24)
    v_mfma_f32_32x32x16_bf16 v[32:47], a[200:203], v[144:147], v[32:47]
    v_mfma_f32_32x32x16_bf16 v[48:63], a[200:203], v[148:151], v[48:63]
    v_mfma_f32_32x32x16_bf16 v[64:79], a[204:207], v[144:147], v[64:79]
    v_mfma_f32_32x32x16_bf16 v[80:95], a[204:207], v[148:151], v[80:95]
    buffer_load_dwordx4 a[200:203], v1, s[20:23], s80 offen offset:0 sc1
    buffer_load_dwordx4 a[204:207], v1, s[20:23], s80 offen offset:1024 sc1
    s_waitcnt vmcnt(24)
    v_mfma_f32_32x32x16_bf16 v[32:47], a[208:211], v[152:155], v[32:47]
    v_mfma_f32_32x32x16_bf16 v[48:63], a[208:211], v[156:159], v[48:63]
    v_mfma_f32_32x32x16_bf16 v[64:79], a[212:215], v[152:155], v[64:79]
    v_mfma_f32_32x32x16_bf16 v[80:95], a[212:215], v[156:159], v[80:95]
    buffer_load_dwordx4 a[208:211], v1, s[20:23], s80 offen offset:2048 sc1
    buffer_load_dwordx4 a[212:215], v1, s[20:23], s80 offen offset:3072 sc1
    s_add_u32 s80, s80, 4096
    s_cmp_ge_u32 s80, s45
    s_cselect_b32 s80, s44, s80
    s_waitcnt vmcnt(24)
    v_mfma_f32_32x32x16_bf16 v[32:47], a[216:219], v[160:163], v[32:47]
    v_mfma_f32_32x32x16_bf16 v[48:63], a[216:219], v[164:167], v[48:63]
    v_mfma_f32_32x32x16_bf16 v[64:79], a[220:223], v[160:163], v[64:79]
    v_mfma_f32_32x32x16_bf16 v[80:95], a[220:223], v[164:167], v[80:95]
    buffer_load_dwordx4 a[216:219], v1, s[20:23], s80 offen offset:0 sc1
    buffer_load_dwordx4 a[220:223], v1, s[20:23], s80 offen offset:1024 sc1
    buffer_load_dwordx4 v[160:163], v1, s[20:23], s80 offen offset:2048 sc1
    buffer_load_dwordx4 v[164:167], v1, s[20:23], s80 offen offset:3072 sc1
    s_add_u32 s80, s80, 4096
    s_cmp_ge_u32 s80, s45
    s_cselect_b32 s80, s44, s80
    s_cmp_eq_u32 s79, 0
    s_cselect_b32 s24, 1, 0
    s_mov_b32 s25, s24
    s_cmp_eq_u32 s78, 0
    s_cselect_b32 s26, -1, 0
    s_mov_b32 s27, 0
    s_waitcnt vmcnt(26)
    v_mfma_f32_32x32x16_bf16 v[96:111], v[208:211], a[0:3], 0
    v_mfma_f32_32x32x16_bf16 v[112:127], v[208:211], a[4:7], 0
    v_mfma_f32_32x32x16_bf16 v[128:143], v[212:215], a[0:3], 0
    v_mfma_f32_32x32x16_bf16 v[144:159], v[212:215], a[4:7], 0
    s_nop 7
    buffer_load_dwordx4 v[208:211], v1, s[20:23], s80 offen offset:0 sc1
    buffer_load_dwordx4 v[212:215], v1, s[20:23], s80 offen offset:1024 sc1
    s_waitcnt vmcnt(26)
    v_mfma_f32_32x32x16_bf16 v[96:111], v[216:219], a[8:11], v[96:111]
    v_sub_f32 v4, v32, v80
    v_add_f32 v5, v32, v80
    v_cndmask_b32 v6, v4, v32, s[24:25]
    v_mfma_f32_32x32x16_bf16 v[112:127], v[216:219], a[12:15], v[112:127]
    v_cndmask_b32 v7, v5, v48, s[24:25]
    v_cndmask_b32 v8, v5, v32, s[24:25]
    v_cndmask_b32 v9, v4, v48, s[24:25]
    v_mfma_f32_32x32x16_bf16 v[128:143], v[220:223], a[8:11], v[128:143]
    v_cndmask_b32 v4, v32, v48, s[24:25]
    v_cndmask_b32 v5, v64, v80, s[24:25]
    v_cndmask_b32 v6, v6, v32, s[26:27]
    v_mfma_f32_32x32x16_bf16 v[144:159], v[220:223], a[12:15], v[144:159]
    v_cndmask_b32 v7, v7, v4, s[26:27]
    v_cndmask_b32 v8, v8, v64, s[26:27]
    v_cndmask_b32 v9, v9, v5, s[26:27]
    buffer_load_dwordx4 v[216:219], v1, s[20:23], s80 offen offset:2048 sc1
    buffer_load_dwordx4 v[220:223], v1, s[20:23], s80 offen offset:3072 sc1
    s_add_u32 s80, s80, 4096
    s_cmp_ge_u32 s80, s45
    s_cselect_b32 s80, s44, s80
    s_waitcnt vmcnt(26)
    v_mfma_f32_32x32x16_bf16 v[96:111], v[16:19], a[16:19], v[96:111]
    v_mul_f32 v32, v224, v6
    v_mul_f32 v48, v224, v7
    v_mul_f32 v64, v240, v8
    v_mfma_f32_32x32x16_bf16 v[112:127], v[16:19], a[20:23], v[112:127]
    v_mul_f32 v80, v240, v9
    v_sub_f32 v4, v33, v81
    v_add_f32 v5, v33, v81
    v_mfma_f32_32x32x16_bf16 v[128:143], v[20:23], a[16:19], v[128:143]
    v_cndmask_b32 v6, v4, v33, s[24:25]
    v_cndmask_b32 v7, v5, v49, s[24:25]
    v_cndmask_b32 v8, v5, v33, s[24:25]
    v_mfma_f32_32x32x16_bf16 v[144:159], v[20:23], a[20:23], v[144:159]
    v_cndmask_b32 v9, v4, v49, s[24:25]
    v_mul_f32 v33, v225, v6
    v_mul_f32 v49, v225, v7
    buffer_load_dwordx4 v[16:19], v1, s[20:23], s80 offen offset:0 sc1
    buffer_load_dwordx4 v[20:23], v1, s[20:23], s80 offen offset:1024 sc1
    s_waitcnt vmcnt(26)
    v_mfma_f32_32x32x16_bf16 v[96:111], v[24:27], a[24:27], v[96:111]
    v_mul_f32 v65, v241, v8
    v_mul_f32 v81, v241, v9
    v_sub_f32 v4, v34, v82
    v_mfma_f32_32x32x16_bf16 v[112:127], v[24:27], a[28:31], v[112:127]
    v_add_f32 v5, v34, v82
    v_cndmask_b32 v6, v4, v34, s[24:25]
    v_cndmask_b32 v7, v5, v50, s[24:25]
    v_mfma_f32_32x32x16_bf16 v[128:143], v[28:31], a[24:27], v[128:143]
    v_cndmask_b32 v8, v5, v34, s[24:25]
    v_cndmask_b32 v9, v4, v50, s[24:25]
    v_mul_f32 v34, v226, v6
    v_mfma_f32_32x32x16_bf16 v[144:159], v[28:31], a[28:31], v[144:159]
    v_mul_f32 v50, v226, v7
    v_mul_f32 v66, v242, v8
    v_mul_f32 v82, v242, v9
    buffer_load_dwordx4 v[24:27], v1, s[20:23], s80 offen offset:2048 sc1
    buffer_load_dwordx4 v[28:31], v1, s[20:23], s80 offen offset:3072 sc1
    s_add_u32 s80, s80, 4096
    s_cmp_ge_u32 s80, s45
    s_cselect_b32 s80, s44, s80
    s_waitcnt vmcnt(26)
    v_mfma_f32_32x32x16_bf16 v[96:111], a[152:155], a[32:35], v[96:111]
    v_sub_f32 v4, v35, v83
    v_add_f32 v5, v35, v83
    v_cndmask_b32 v6, v4, v35, s[24:25]
    v_mfma_f32_32x32x16_bf16 v[112:127], a[152:155], a[36:39], v[112:127]
    v_cndmask_b32 v7, v5, v51, s[24:25]
    v_cndmask_b32 v8, v5, v35, s[24:25]
    v_cndmask_b32 v9, v4, v51, s[24:25]
    v_mfma_f32_32x32x16_bf16 v[128:143], a[156:159], a[32:35], v[128:143]
    v_mul_f32 v35, v227, v6
    v_mul_f32 v51, v227, v7
    v_mul_f32 v67, v243, v8
    v_mfma_f32_32x32x16_bf16 v[144:159], a[156:159], a[36:39], v[144:159]
    v_mul_f32 v83, v243, v9
    v_sub_f32 v4, v36, v84
    v_add_f32 v5, v36, v84
    buffer_load_dwordx4 a[152:155], v1, s[20:23], s80 offen offset:0 sc1
    buffer_load_dwordx4 a[156:159], v1, s[20:23], s80 offen offset:1024 sc1
    s_waitcnt vmcnt(26)
    v_mfma_f32_32x32x16_bf16 v[96:111], a[160:163], a[40:43], v[96:111]
    v_cndmask_b32 v6, v4, v36, s[24:25]
    v_cndmask_b32 v7, v5, v52, s[24:25]
    v_cndmask_b32 v8, v5, v36, s[24:25]
    v_mfma_f32_32x32x16_bf16 v[112:127], a[160:163], a[44:47], v[112:127]
    v_cndmask_b32 v9, v4, v52, s[24:25]
    v_mul_f32 v36, v228, v6
    v_mul_f32 v52, v228, v7
    v_mfma_f32_32x32x16_bf16 v[128:143], a[164:167], a[40:43], v[128:143]
    v_mul_f32 v68, v244, v8
    v_mul_f32 v84, v244, v9
    v_sub_f32 v4, v37, v85
    v_mfma_f32_32x32x16_bf16 v[144:159], a[164:167], a[44:47], v[144:159]
    v_add_f32 v5, v37, v85
    v_cndmask_b32 v6, v4, v37, s[24:25]
    v_cndmask_b32 v7, v5, v53, s[24:25]
    buffer_load_dwordx4 a[160:163], v1, s[20:23], s80 offen offset:2048 sc1
    buffer_load_dwordx4 a[164:167], v1, s[20:23], s80 offen offset:3072 sc1
    s_add_u32 s80, s80, 4096
    s_cmp_ge_u32 s80, s45
    s_cselect_b32 s80, s44, s80
    s_waitcnt vmcnt(26)
    v_mfma_f32_32x32x16_bf16 v[96:111], a[168:171], a[48:51], v[96:111]
    v_cndmask_b32 v8, v5, v37, s[24:25]
    v_cndmask_b32 v9, v4, v53, s[24:25]
    v_mul_f32 v37, v229, v6
    v_mfma_f32_32x32x16_bf16 v[112:127], a[168:171], a[52:55], v[112:127]
    v_mul_f32 v53, v229, v7
    v_mul_f32 v69, v245, v8
    v_mul_f32 v85, v245, v9
    v_mfma_f32_32x32x16_bf16 v[128:143], a[172:175], a[48:51], v[128:143]
    v_sub_f32 v4, v38, v86
    v_add_f32 v5, v38, v86
    v_cndmask_b32 v6, v4, v38, s[24:25]
    v_mfma_f32_32x32x16_bf16 v[144:159], a[172:175], a[52:55], v[144:159]
    v_cndmask_b32 v7, v5, v54, s[24:25]
    v_cndmask_b32 v8, v5, v38, s[24:25]
    v_cndmask_b32 v9, v4, v54, s[24:25]
    buffer_load_dwordx4 a[168:171], v1, s[20:23], s80 offen offset:0 sc1
    buffer_load_dwordx4 a[172:175], v1, s[20:23], s80 offen offset:1024 sc1
    s_waitcnt vmcnt(26)
    v_mfma_f32_32x32x16_bf16 v[96:111], a[176:179], a[56:59], v[96:111]
    v_mul_f32 v38, v230, v6
    v_mul_f32 v54, v230, v7
    v_mul_f32 v70, v246, v8
    v_mfma_f32_32x32x16_bf16 v[112:127], a[176:179], a[60:63], v[112:127]
    v_mul_f32 v86, v246, v9
    v_sub_f32 v4, v39, v87
    v_add_f32 v5, v39, v87
    v_mfma_f32_32x32x16_bf16 v[128:143], a[180:183], a[56:59], v[128:143]
    v_cndmask_b32 v6, v4, v39, s[24:25]
    v_cndmask_b32 v7, v5, v55, s[24:25]
    v_cndmask_b32 v8, v5, v39, s[24:25]
    v_mfma_f32_32x32x16_bf16 v[144:159], a[180:183], a[60:63], v[144:159]
    v_cndmask_b32 v9, v4, v55, s[24:25]
    v_mul_f32 v39, v231, v6
    v_mul_f32 v55, v231, v7
    buffer_load_dwordx4 a[176:179], v1, s[20:23], s80 offen offset:2048 sc1
    buffer_load_dwordx4 a[180:183], v1, s[20:23], s80 offen offset:3072 sc1
    s_add_u32 s80, s80, 4096
    s_cmp_ge_u32 s80, s45
    s_cselect_b32 s80, s44, s80
    s_waitcnt vmcnt(26)
    v_mfma_f32_32x32x16_bf16 v[96:111], a[184:187], a[64:67], v[96:111]
    v_mul_f32 v71, v247, v8
    v_mul_f32 v87, v247, v9
    v_sub_f32 v4, v40, v88
    v_mfma_f32_32x32x16_bf16 v[112:127], a[184:187], a[68:71], v[112:127]
    v_add_f32 v5, v40, v88
    v_cndmask_b32 v6, v4, v40, s[24:25]
    v_cndmask_b32 v7, v5, v56, s[24:25]
    v_mfma_f32_32x32x16_bf16 v[128:143], a[188:191], a[64:67], v[128:143]
    v_cndmask_b32 v8, v5, v40, s[24:25]
    v_cndmask_b32 v9, v4, v56, s[24:25]
    v_mul_f32 v40, v232, v6
    v_mfma_f32_32x32x16_bf16 v[144:159], a[188:191], a[68:71], v[144:159]
    v_mul_f32 v56, v232, v7
    v_mul_f32 v72, v248, v8
    v_mul_f32 v88, v248, v9
    buffer_load_dwordx4 a[184:187], v1, s[20:23], s80 offen offset:0 sc1
    buffer_load_dwordx4 a[188:191], v1, s[20:23], s80 offen offset:1024 sc1
    s_waitcnt vmcnt(26)
    v_mfma_f32_32x32x16_bf16 v[96:111], a[192:195], a[72:75], v[96:111]
    v_sub_f32 v4, v41, v89
    v_add_f32 v5, v41, v89
    v_cndmask_b32 v6, v4, v41, s[24:25]
    v_mfma_f32_32x32x16_bf16 v[112:127], a[192:195], a[76:79], v[112:127]
    v_cndmask_b32 v7, v5, v57, s[24:25]
    v_cndmask_b32 v8, v5, v41, s[24:25]
    v_cndmask_b32 v9, v4, v57, s[24:25]
    v_mfma_f32_32x32x16_bf16 v[128:143], a[196:199], a[72:75], v[128:143]
    v_mul_f32 v41, v233, v6
    v_mul_f32 v57, v233, v7
    v_mul_f32 v73, v249, v8
    v_mfma_f32_32x32x16_bf16 v[144:159], a[196:199], a[76:79], v[144:159]
    v_mul_f32 v89, v249, v9
    v_sub_f32 v4, v42, v90
    v_add_f32 v5, v42, v90
    buffer_load_dwordx4 a[192:195], v1, s[20:23], s80 offen offset:2048 sc1
    buffer_load_dwordx4 a[196:199], v1, s[20:23], s80 offen offset:3072 sc1
    s_add_u32 s80, s80, 4096
    s_cmp_ge_u32 s80, s45
    s_cselect_b32 s80, s44, s80
    s_waitcnt vmcnt(26)
    v_mfma_f32_32x32x16_bf16 v[96:111], a[200:203], a[80:83], v[96:111]
    v_cndmask_b32 v6, v4, v42, s[24:25]
    v_cndmask_b32 v7, v5, v58, s[24:25]
    v_cndmask_b32 v8, v5, v42, s[24:25]
    v_mfma_f32_32x32x16_bf16 v[112:127], a[200:203], a[84:87], v[112:127]
    v_cndmask_b32 v9, v4, v58, s[24:25]
    v_mul_f32 v42, v234, v6
    v_mul_f32 v58, v234, v7
    v_mfma_f32_32x32x16_bf16 v[128:143], a[204:207], a[80:83], v[128:143]
    v_mul_f32 v74, v250, v8
    v_mul_f32 v90, v250, v9
    v_sub_f32 v4, v43, v91
    v_mfma_f32_32x32x16_bf16 v[144:159], a[204:207], a[84:87], v[144:159]
    v_add_f32 v5, v43, v91
    v_cndmask_b32 v6, v4, v43, s[24:25]
    v_cndmask_b32 v7, v5, v59, s[24:25]
    buffer_load_dwordx4 a[200:203], v1, s[20:23], s80 offen offset:0 sc1
    buffer_load_dwordx4 a[204:207], v1, s[20:23], s80 offen offset:1024 sc1
    s_waitcnt vmcnt(26)
    v_mfma_f32_32x32x16_bf16 v[96:111], a[208:211], a[88:91], v[96:111]
    v_cndmask_b32 v8, v5, v43, s[24:25]
    v_cndmask_b32 v9, v4, v59, s[24:25]
    v_mul_f32 v43, v235, v6
    v_mfma_f32_32x32x16_bf16 v[112:127], a[208:211], a[92:95], v[112:127]
    v_mul_f32 v59, v235, v7
    v_mul_f32 v75, v251, v8
    v_mul_f32 v91, v251, v9
    v_mfma_f32_32x32x16_bf16 v[128:143], a[212:215], a[88:91], v[128:143]
    v_sub_f32 v4, v44, v92
    v_add_f32 v5, v44, v92
    v_cndmask_b32 v6, v4, v44, s[24:25]
    v_mfma_f32_32x32x16_bf16 v[144:159], a[212:215], a[92:95], v[144:159]
    v_cndmask_b32 v7, v5, v60, s[24:25]
    v_cndmask_b32 v8, v5, v44, s[24:25]
    v_cndmask_b32 v9, v4, v60, s[24:25]
    buffer_load_dwordx4 a[208:211], v1, s[20:23], s80 offen offset:2048 sc1
    buffer_load_dwordx4 a[212:215], v1, s[20:23], s80 offen offset:3072 sc1
    s_add_u32 s80, s80, 4096
    s_cmp_ge_u32 s80, s45
    s_cselect_b32 s80, s44, s80
    s_waitcnt vmcnt(26)
    v_mfma_f32_32x32x16_bf16 v[96:111], a[216:219], a[96:99], v[96:111]
    v_mul_f32 v44, v236, v6
    v_mul_f32 v60, v236, v7
    v_mul_f32 v76, v252, v8
    v_mfma_f32_32x32x16_bf16 v[112:127], a[216:219], a[100:103], v[112:127]
    v_mul_f32 v92, v252, v9
    v_sub_f32 v4, v45, v93
    v_add_f32 v5, v45, v93
    v_mfma_f32_32x32x16_bf16 v[128:143], a[220:223], a[96:99], v[128:143]
    v_cndmask_b32 v6, v4, v45, s[24:25]
    v_cndmask_b32 v7, v5, v61, s[24:25]
    v_cndmask_b32 v8, v5, v45, s[24:25]
    v_mfma_f32_32x32x16_bf16 v[144:159], a[220:223], a[100:103], v[144:159]
    v_cndmask_b32 v9, v4, v61, s[24:25]
    v_mul_f32 v45, v237, v6
    v_mul_f32 v61, v237, v7
    buffer_load_dwordx4 a[216:219], v1, s[20:23], s80 offen offset:0 sc1
    buffer_load_dwordx4 a[220:223], v1, s[20:23], s80 offen offset:1024 sc1
    s_waitcnt vmcnt(26)
    v_mfma_f32_32x32x16_bf16 v[96:111], v[160:163], a[104:107], v[96:111]
    v_mul_f32 v77, v253, v8
    v_mul_f32 v93, v253, v9
    v_sub_f32 v4, v46, v94
    v_mfma_f32_32x32x16_bf16 v[112:127], v[160:163], a[108:111], v[112:127]
    v_add_f32 v5, v46, v94
    v_cndmask_b32 v6, v4, v46, s[24:25]
    v_cndmask_b32 v7, v5, v62, s[24:25]
    v_mfma_f32_32x32x16_bf16 v[128:143], v[164:167], a[104:107], v[128:143]
    v_cndmask_b32 v8, v5, v46, s[24:25]
    v_cndmask_b32 v9, v4, v62, s[24:25]
    v_mul_f32 v46, v238, v6
    v_mfma_f32_32x32x16_bf16 v[144:159], v[164:167], a[108:111], v[144:159]
    v_mul_f32 v62, v238, v7
    v_mul_f32 v78, v254, v8
    v_mul_f32 v94, v254, v9
    buffer_load_dwordx4 v[160:163], v1, s[20:23], s80 offen offset:2048 sc1
    buffer_load_dwordx4 v[164:167], v1, s[20:23], s80 offen offset:3072 sc1
    s_add_u32 s80, s80, 4096
    s_cmp_ge_u32 s80, s45
    s_cselect_b32 s80, s44, s80
    s_waitcnt vmcnt(26)
    v_mfma_f32_32x32x16_bf16 v[96:111], v[208:211], a[112:115], v[96:111]
    v_sub_f32 v4, v47, v95
    v_add_f32 v5, v47, v95
    v_cndmask_b32 v6, v4, v47, s[24:25]
    v_mfma_f32_32x32x16_bf16 v[112:127], v[208:211], a[116:119], v[112:127]
    v_cndmask_b32 v7, v5, v63, s[24:25]
    v_cndmask_b32 v8, v5, v47, s[24:25]
    v_cndmask_b32 v9, v4, v63, s[24:25]
    v_mfma_f32_32x32x16_bf16 v[128:143], v[212:215], a[112:115], v[128:143]
    v_mul_f32 v47, v239, v6
    v_mul_f32 v63, v239, v7
    v_mul_f32 v79, v255, v8
    v_mfma_f32_32x32x16_bf16 v[144:159], v[212:215], a[116:119], v[144:159]
    v_mul_f32 v95, v255, v9
    s_waitcnt vmcnt(24)
    v_mfma_f32_32x32x16_bf16 v[96:111], v[216:219], a[120:123], v[96:111]
    v_mfma_f32_32x32x16_bf16 v[112:127], v[216:219], a[124:127], v[112:127]
    v_mfma_f32_32x32x16_bf16 v[128:143], v[220:223], a[120:123], v[128:143]
    v_mfma_f32_32x32x16_bf16 v[144:159], v[220:223], a[124:127], v[144:159]
    s_waitcnt vmcnt(22)
    v_mfma_f32_32x32x16_bf16 v[96:111], v[16:19], a[128:131], v[96:111]
    v_mfma_f32_32x32x16_bf16 v[112:127], v[16:19], a[132:135], v[112:127]
    v_mfma_f32_32x32x16_bf16 v[128:143], v[20:23], a[128:131], v[128:143]
    v_mfma_f32_32x32x16_bf16 v[144:159], v[20:23], a[132:135], v[144:159]
    s_waitcnt vmcnt(20)
    v_mfma_f32_32x32x16_bf16 v[96:111], v[24:27], a[136:139], v[96:111]
    v_mfma_f32_32x32x16_bf16 v[112:127], v[24:27], a[140:143], v[112:127]
    v_mfma_f32_32x32x16_bf16 v[128:143], v[28:31], a[136:139], v[128:143]
    v_mfma_f32_32x32x16_bf16 v[144:159], v[28:31], a[140:143], v[144:159]
    s_waitcnt vmcnt(18)
    v_mfma_f32_32x32x16_bf16 v[96:111], a[152:155], a[144:147], v[96:111]
    v_mfma_f32_32x32x16_bf16 v[112:127], a[152:155], a[148:151], v[112:127]
    v_mfma_f32_32x32x16_bf16 v[128:143], a[156:159], a[144:147], v[128:143]
    v_mfma_f32_32x32x16_bf16 v[144:159], a[156:159], a[148:151], v[144:159]
    s_waitcnt vmcnt(16)
    v_mfma_f32_32x32x16_bf16 v[96:111], a[160:163], a[224:227], v[96:111]
    v_mfma_f32_32x32x16_bf16 v[112:127], a[160:163], a[228:231], v[112:127]
    v_mfma_f32_32x32x16_bf16 v[128:143], a[164:167], a[224:227], v[128:143]
    v_mfma_f32_32x32x16_bf16 v[144:159], a[164:167], a[228:231], v[144:159]
    s_waitcnt vmcnt(14)
    v_mfma_f32_32x32x16_bf16 v[96:111], a[168:171], a[232:235], v[96:111]
    v_mfma_f32_32x32x16_bf16 v[112:127], a[168:171], a[236:239], v[112:127]
    v_mfma_f32_32x32x16_bf16 v[128:143], a[172:175], a[232:235], v[128:143]
    v_mfma_f32_32x32x16_bf16 v[144:159], a[172:175], a[236:239], v[144:159]
    s_waitcnt vmcnt(12)
    v_mfma_f32_32x32x16_bf16 v[96:111], a[176:179], a[240:243], v[96:111]
    v_mfma_f32_32x32x16_bf16 v[112:127], a[176:179], a[244:247], v[112:127]
    v_mfma_f32_32x32x16_bf16 v[128:143], a[180:183], a[240:243], v[128:143]
    v_mfma_f32_32x32x16_bf16 v[144:159], a[180:183], a[244:247], v[144:159]
    s_waitcnt vmcnt(10)
    v_mfma_f32_32x32x16_bf16 v[96:111], a[184:187], a[248:251], v[96:111]
    v_mfma_f32_32x32x16_bf16 v[112:127], a[184:187], a[252:255], v[112:127]
    v_mfma_f32_32x32x16_bf16 v[128:143], a[188:191], a[248:251], v[128:143]
    v_mfma_f32_32x32x16_bf16 v[144:159], a[188:191], a[252:255], v[144:159]
    s_waitcnt vmcnt(8)
    v_mfma_f32_32x32x16_bf16 v[96:111], a[192:195], v[168:171], v[96:111]
    v_mfma_f32_32x32x16_bf16 v[112:127], a[192:195], v[172:175], v[112:127]
    v_mfma_f32_32x32x16_bf16 v[128:143], a[196:199], v[168:171], v[128:143]
    v_mfma_f32_32x32x16_bf16 v[144:159], a[196:199], v[172:175], v[144:159]
    s_waitcnt vmcnt(6)
    v_mfma_f32_32x32x16_bf16 v[96:111], a[200:203], v[176:179], v[96:111]
    v_mfma_f32_32x32x16_bf16 v[112:127], a[200:203], v[180:183], v[112:127]
    v_mfma_f32_32x32x16_bf16 v[128:143], a[204:207], v[176:179], v[128:143]
    v_mfma_f32_32x32x16_bf16 v[144:159], a[204:207], v[180:183], v[144:159]
    s_waitcnt vmcnt(4)
    v_mfma_f32_32x32x16_bf16 v[96:111], a[208:211], v[184:187], v[96:111]
    v_mfma_f32_32x32x16_bf16 v[112:127], a[208:211], v[188:191], v[112:127]
    v_mfma_f32_32x32x16_bf16 v[128:143], a[212:215], v[184:187], v[128:143]
    v_mfma_f32_32x32x16_bf16 v[144:159], a[212:215], v[188:191], v[144:159]
    s_waitcnt vmcnt(2)
    v_mfma_f32_32x32x16_bf16 v[96:111], a[216:219], v[192:195], v[96:111]
    v_mfma_f32_32x32x16_bf16 v[112:127], a[216:219], v[196:199], v[112:127]
    v_mfma_f32_32x32x16_bf16 v[128:143], a[220:223], v[192:195], v[128:143]
    v_mfma_f32_32x32x16_bf16 v[144:159], a[220:223], v[196:199], v[144:159]
    s_waitcnt vmcnt(0)
    v_mfma_f32_32x32x16_bf16 v[96:111], v[160:163], v[200:203], v[96:111]
    v_mfma_f32_32x32x16_bf16 v[112:127], v[160:163], v[204:207], v[112:127]
    v_mfma_f32_32x32x16_bf16 v[128:143], v[164:167], v[200:203], v[128:143]
    v_mfma_f32_32x32x16_bf16 v[144:159], v[164:167], v[204:207], v[144:159]
    s_mov_b32 s8, s60
    s_mov_b32 s9, s61
    s_mov_b32 s10, 2097152
    s_mov_b32 s11, 0x00020000
    s_lshl_b32 s12, s3, 12
    v_add_u32 v2, s12, v1
    v_and_b32 v3, 31, v0
    s_lshl_b32 s12, s79, 5
    v_add_u32 v3, s12, v3
    v_sub_u32 v4, 0x200, v3
    v_mov_b32 v5, 0x100
    v_cndmask_b32 v4, v4, v5, s[24:25]
    s_and_b32 s12, s3, 1
    s_cselect_b64 s[28:29], -1, 0
    v_cndmask_b32 v3, v3, v4, s[28:29]
    v_lshrrev_b32 v4, 5, v0
    v_lshl_add_u32 v4, v4, 3, s70
    v_pk_add_f32 v[32:33], v[32:33], v[96:97]
    v_pk_add_f32 v[34:35], v[34:35], v[98:99]
    v_pk_add_f32 v[36:37], v[36:37], v[100:101]
    v_pk_add_f32 v[38:39], v[38:39], v[102:103]
    v_pk_add_f32 v[40:41], v[40:41], v[104:105]
    v_pk_add_f32 v[42:43], v[42:43], v[106:107]
    v_pk_add_f32 v[44:45], v[44:45], v[108:109]
    v_pk_add_f32 v[46:47], v[46:47], v[110:111]
    ds_write_b128 v2, v[32:35] offset:0
    ds_write_b128 v2, v[36:39] offset:1024
    ds_write_b128 v2, v[40:43] offset:2048
    ds_write_b128 v2, v[44:47] offset:3072
    v_pk_add_f32 v[48:49], v[48:49], v[112:113]
    v_pk_add_f32 v[50:51], v[50:51], v[114:115]
    v_pk_add_f32 v[52:53], v[52:53], v[116:117]
    v_pk_add_f32 v[54:55], v[54:55], v[118:119]
    v_pk_add_f32 v[56:57], v[56:57], v[120:121]
    v_pk_add_f32 v[58:59], v[58:59], v[122:123]
    v_pk_add_f32 v[60:61], v[60:61], v[124:125]
    v_pk_add_f32 v[62:63], v[62:63], v[126:127]
    ds_write_b128 v2, v[48:51] offset:16384
    ds_write_b128 v2, v[52:55] offset:17408
    ds_write_b128 v2, v[56:59] offset:18432
    ds_write_b128 v2, v[60:63] offset:19456
    v_pk_add_f32 v[64:65], v[64:65], v[128:129]
    v_pk_add_f32 v[66:67], v[66:67], v[130:131]
    v_pk_add_f32 v[68:69], v[68:69], v[132:133]
    v_pk_add_f32 v[70:71], v[70:71], v[134:135]
    v_pk_add_f32 v[72:73], v[72:73], v[136:137]
    v_pk_add_f32 v[74:75], v[74:75], v[138:139]
    v_pk_add_f32 v[76:77], v[76:77], v[140:141]
    v_pk_add_f32 v[78:79], v[78:79], v[142:143]
    ds_write_b128 v2, v[64:67] offset:32768
    ds_write_b128 v2, v[68:71] offset:33792
    ds_write_b128 v2, v[72:75] offset:34816
    ds_write_b128 v2, v[76:79] offset:35840
    v_pk_add_f32 v[80:81], v[80:81], v[144:145]
    v_pk_add_f32 v[82:83], v[82:83], v[146:147]
    v_pk_add_f32 v[84:85], v[84:85], v[148:149]
    v_pk_add_f32 v[86:87], v[86:87], v[150:151]
    v_pk_add_f32 v[88:89], v[88:89], v[152:153]
    v_pk_add_f32 v[90:91], v[90:91], v[154:155]
    v_pk_add_f32 v[92:93], v[92:93], v[156:157]
    v_pk_add_f32 v[94:95], v[94:95], v[158:159]
    ds_write_b128 v2, v[80:83] offset:49152
    ds_write_b128 v2, v[84:87] offset:50176
    ds_write_b128 v2, v[88:91] offset:51200
    ds_write_b128 v2, v[92:95] offset:52224
    s_lshl_b32 s12, s3, 14
    v_add_u32 v2, s12, v1
    v_sub_u32 v5, 0x800, v4
    s_movk_i32 s12, 0x800
    s_cmp_ge_u32 s3, 2
    s_cselect_b64 s[28:29], -1, 0
    s_cselect_b32 s12, 0xfffff800, s12
    s_mul_i32 s13, s12, 5
    s_and_b64 s[26:27], s[26:27], s[28:29]
    v_cndmask_b32 v4, v4, v5, s[28:29]
    v_lshlrev_b32 v3, 1, v3
    v_lshl_add_u32 v4, v4, 10, v3
    v_add_u32 v5, 0x100000, v3
    v_cndmask_b32 v5, v4, v5, s[26:27]
    v_add_u32 v7, s12, v4
    v_add_u32 v8, s12, v7
    v_add_u32 v9, s12, v8
    v_add_u32 v10, s13, v9
    v_add_u32 v11, s12, v10
    v_add_u32 v12, s12, v11
    v_add_u32 v13, s12, v12
    v_add_u32 v14, s13, v13
    v_add_u32 v15, s12, v14
    v_add_u32 v16, s12, v15
    v_add_u32 v17, s12, v16
    v_add_u32 v18, s13, v17
    v_add_u32 v19, s12, v18
    v_add_u32 v20, s12, v19
    v_add_u32 v21, s12, v20
    s_waitcnt lgkmcnt(0)
    s_barrier
    ds_read_b128 v[32:35], v2 offset:0
    ds_read_b128 v[48:51], v2 offset:4096
    ds_read_b128 v[64:67], v2 offset:8192
    ds_read_b128 v[80:83], v2 offset:12288
    ds_read_b128 v[36:39], v2 offset:1024
    ds_read_b128 v[52:55], v2 offset:5120
    ds_read_b128 v[68:71], v2 offset:9216
    ds_read_b128 v[84:87], v2 offset:13312
    ds_read_b128 v[40:43], v2 offset:2048
    ds_read_b128 v[56:59], v2 offset:6144
    ds_read_b128 v[72:75], v2 offset:10240
    ds_read_b128 v[88:91], v2 offset:14336
    ds_read_b128 v[44:47], v2 offset:3072
    ds_read_b128 v[60:63], v2 offset:7168
    ds_read_b128 v[76:79], v2 offset:11264
    ds_read_b128 v[92:95], v2 offset:15360
    s_waitcnt lgkmcnt(12)
    v_add_f32 v32, v32, v48
    v_add_f32 v64, v64, v80
    v_add_f32 v33, v33, v49
    v_add_f32 v65, v65, v81
    v_add_f32 v34, v34, v50
    v_add_f32 v66, v66, v82
    v_add_f32 v35, v35, v51
    v_add_f32 v67, v67, v83
    v_add_f32 v32, v32, v64
    v_add_f32 v33, v33, v65
    v_add_f32 v34, v34, v66
    v_add_f32 v35, v35, v67
    v_cvt_pk_bf16_f32 v96, v32, v33
    v_cvt_pk_bf16_f32 v97, v34, v35
    buffer_store_short v96, v5, s[8:11], 0 offen nt
    buffer_store_short_d16_hi v96, v7, s[8:11], 0 offen nt
    buffer_store_short v97, v8, s[8:11], 0 offen nt
    buffer_store_short_d16_hi v97, v9, s[8:11], 0 offen nt
    s_waitcnt lgkmcnt(8)
    v_add_f32 v36, v36, v52
    v_add_f32 v68, v68, v84
    v_add_f32 v37, v37, v53
    v_add_f32 v69, v69, v85
    v_add_f32 v38, v38, v54
    v_add_f32 v70, v70, v86
    v_add_f32 v39, v39, v55
    v_add_f32 v71, v71, v87
    v_add_f32 v36, v36, v68
    v_add_f32 v37, v37, v69
    v_add_f32 v38, v38, v70
    v_add_f32 v39, v39, v71
    v_cvt_pk_bf16_f32 v98, v36, v37
    v_cvt_pk_bf16_f32 v99, v38, v39
    buffer_store_short v98, v10, s[8:11], 0 offen nt
    buffer_store_short_d16_hi v98, v11, s[8:11], 0 offen nt
    buffer_store_short v99, v12, s[8:11], 0 offen nt
    buffer_store_short_d16_hi v99, v13, s[8:11], 0 offen nt
    s_waitcnt lgkmcnt(4)
    v_add_f32 v40, v40, v56
    v_add_f32 v72, v72, v88
    v_add_f32 v41, v41, v57
    v_add_f32 v73, v73, v89
    v_add_f32 v42, v42, v58
    v_add_f32 v74, v74, v90
    v_add_f32 v43, v43, v59
    v_add_f32 v75, v75, v91
    v_add_f32 v40, v40, v72
    v_add_f32 v41, v41, v73
    v_add_f32 v42, v42, v74
    v_add_f32 v43, v43, v75
    v_cvt_pk_bf16_f32 v100, v40, v41
    v_cvt_pk_bf16_f32 v101, v42, v43
    buffer_store_short v100, v14, s[8:11], 0 offen nt
    buffer_store_short_d16_hi v100, v15, s[8:11], 0 offen nt
    buffer_store_short v101, v16, s[8:11], 0 offen nt
    buffer_store_short_d16_hi v101, v17, s[8:11], 0 offen nt
    s_waitcnt lgkmcnt(0)
    v_add_f32 v44, v44, v60
    v_add_f32 v76, v76, v92
    v_add_f32 v45, v45, v61
    v_add_f32 v77, v77, v93
    v_add_f32 v46, v46, v62
    v_add_f32 v78, v78, v94
    v_add_f32 v47, v47, v63
    v_add_f32 v79, v79, v95
    v_add_f32 v44, v44, v76
    v_add_f32 v45, v45, v77
    v_add_f32 v46, v46, v78
    v_add_f32 v47, v47, v79
    v_cvt_pk_bf16_f32 v102, v44, v45
    v_cvt_pk_bf16_f32 v103, v46, v47
    buffer_store_short v102, v18, s[8:11], 0 offen nt
    buffer_store_short_d16_hi v102, v19, s[8:11], 0 offen nt
    buffer_store_short v103, v20, s[8:11], 0 offen nt
    buffer_store_short_d16_hi v103, v21, s[8:11], 0 offen nt
K_END:
    s_endpgm
P1_DFT:
    s_barrier
    ds_read_b64_tr_b16 v[176:177], v12 offset:0
    ds_read_b64_tr_b16 v[178:179], v12 offset:1024
    ds_read_b64_tr_b16 v[180:181], v12 offset:16384
    ds_read_b64_tr_b16 v[182:183], v12 offset:17408
    ds_read_b128 v[160:163], v8 offset:0
    ds_read_b128 v[164:167], v8 offset:4096
    ds_read_b128 v[168:171], v8 offset:8192
    ds_read_b128 v[172:175], v8 offset:12288
    s_waitcnt lgkmcnt(0)
    v_mfma_f32_32x32x16_bf16 v[32:47], v[160:163], v[176:179], 0
    ds_read_b64_tr_b16 v[200:201], v12 offset:4096
    v_cvt_f32_u32 v209, v209
    v_cvt_f32_u32 v208, v208
    v_mfma_f32_32x32x16_bf16 v[48:63], v[160:163], v[180:183], 0
    ds_read_b64_tr_b16 v[202:203], v12 offset:5120
    v_mul_f32 v209, 0x3a000000, v209
    v_mul_f32 v208, 0x3a000000, v208
    s_add_u32 m0, s73, 32768
    s_nop 0
    buffer_load_dwordx4 v2, s[8:11], s74 offen lds
    v_mfma_f32_32x32x16_bf16 v[64:79], v[164:167], v[176:179], 0
    ds_read_b64_tr_b16 v[204:205], v12 offset:20480
    v_mul_f32 v210, 0x41100000, v208
    v_mov_b32 v211, 0xbf803f80
    v_mfma_f32_32x32x16_bf16 v[80:95], v[164:167], v[180:183], 0
    ds_read_b64_tr_b16 v[206:207], v12 offset:21504
    v_fract_f32 v209, v209
    v_add_f32 v212, v209, v208
    s_add_u32 m0, s73, 33792
    s_nop 0
    buffer_load_dwordx4 v3, s[8:11], s74 offen lds
    v_mfma_f32_32x32x16_bf16 v[96:111], v[168:171], v[176:179], 0
    ds_read_b128 v[184:187], v9 offset:0
    v_cos_f32 v213, v209
    v_sin_f32 v214, -v209
    v_mfma_f32_32x32x16_bf16 v[112:127], v[168:171], v[180:183], 0
    ds_read_b128 v[188:191], v9 offset:4096
    v_add_f32 v209, v212, v208
    v_cos_f32 v215, v212
    s_add_u32 m0, s73, 34816
    s_nop 0
    buffer_load_dwordx4 v4, s[8:11], s74 offen lds
    v_mfma_f32_32x32x16_bf16 v[128:143], v[172:175], v[176:179], 0
    ds_read_b128 v[192:195], v9 offset:8192
    v_sin_f32 v216, -v212
    v_cvt_pk_bf16_f32 v217, v213, v215
    v_mfma_f32_32x32x16_bf16 v[144:159], v[172:175], v[180:183], 0
    ds_read_b128 v[196:199], v9 offset:12288
    v_cvt_pk_bf16_f32 v218, v214, v216
    v_accvgpr_write_b32 a152, v217
    s_add_u32 m0, s73, 35840
    s_nop 0
    buffer_load_dwordx4 v5, s[8:11], s74 offen lds
    s_add_u32 s74, s74, 128
    s_and_b32 s74, s74, 0x3ff
    s_waitcnt lgkmcnt(0)
    v_mfma_f32_32x32x16_bf16 v[32:47], v[184:187], v[200:203], v[32:47]
    ds_read_b64_tr_b16 v[176:177], v12 offset:8192
    v_cndmask_b32 v218, v218, v211, s[64:65]
    v_accvgpr_write_b32 a156, v218
    v_mfma_f32_32x32x16_bf16 v[48:63], v[184:187], v[204:207], v[48:63]
    ds_read_b64_tr_b16 v[178:179], v12 offset:9216
    v_add_f32 v212, v209, v208
    v_cos_f32 v213, v209
    s_add_u32 m0, s73, 114688
    s_nop 0
    buffer_load_dwordx4 v6, s[12:15], s75 offen lds
    v_mfma_f32_32x32x16_bf16 v[64:79], v[188:191], v[200:203], v[64:79]
    ds_read_b64_tr_b16 v[180:181], v12 offset:24576
    v_sin_f32 v214, -v209
    v_add_f32 v209, v212, v208
    v_mfma_f32_32x32x16_bf16 v[80:95], v[188:191], v[204:207], v[80:95]
    ds_read_b64_tr_b16 v[182:183], v12 offset:25600
    v_cos_f32 v215, v212
    v_sin_f32 v216, -v212
    s_add_u32 m0, s73, 131072
    s_nop 0
    buffer_load_dwordx4 v7, s[16:19], s75 offen lds
    s_add_u32 s75, s75, s71
    v_mfma_f32_32x32x16_bf16 v[96:111], v[192:195], v[200:203], v[96:111]
    ds_read_b128 v[160:163], v10 offset:0
    v_cvt_pk_bf16_f32 v217, v213, v215
    v_cvt_pk_bf16_f32 v218, v214, v216
    v_mfma_f32_32x32x16_bf16 v[112:127], v[192:195], v[204:207], v[112:127]
    ds_read_b128 v[164:167], v10 offset:4096
    v_accvgpr_write_b32 a153, v217
    v_cndmask_b32 v218, v218, v211, s[64:65]
    s_add_u32 m0, s73, 115712
    s_nop 0
    buffer_load_dwordx4 v6, s[12:15], s75 offen lds
    v_mfma_f32_32x32x16_bf16 v[128:143], v[196:199], v[200:203], v[128:143]
    ds_read_b128 v[168:171], v10 offset:8192
    v_accvgpr_write_b32 a157, v218
    v_add_f32 v212, v209, v208
    v_mfma_f32_32x32x16_bf16 v[144:159], v[196:199], v[204:207], v[144:159]
    ds_read_b128 v[172:175], v10 offset:12288
    v_cos_f32 v213, v209
    v_sin_f32 v214, -v209
    s_add_u32 m0, s73, 132096
    s_nop 0
    buffer_load_dwordx4 v7, s[16:19], s75 offen lds
    s_add_u32 s75, s75, s71
    s_waitcnt lgkmcnt(0)
    v_mfma_f32_32x32x16_bf16 v[32:47], v[160:163], v[176:179], v[32:47]
    ds_read_b64_tr_b16 v[200:201], v12 offset:12288
    v_add_f32 v209, v212, v208
    v_cos_f32 v215, v212
    v_mfma_f32_32x32x16_bf16 v[48:63], v[160:163], v[180:183], v[48:63]
    ds_read_b64_tr_b16 v[202:203], v12 offset:13312
    v_sin_f32 v216, -v212
    v_cvt_pk_bf16_f32 v217, v213, v215
    s_add_u32 m0, s73, 116736
    s_nop 0
    buffer_load_dwordx4 v6, s[12:15], s75 offen lds
    v_mfma_f32_32x32x16_bf16 v[64:79], v[164:167], v[176:179], v[64:79]
    ds_read_b64_tr_b16 v[204:205], v12 offset:28672
    v_cvt_pk_bf16_f32 v218, v214, v216
    v_accvgpr_write_b32 a154, v217
    v_mfma_f32_32x32x16_bf16 v[80:95], v[164:167], v[180:183], v[80:95]
    ds_read_b64_tr_b16 v[206:207], v12 offset:29696
    v_cndmask_b32 v218, v218, v211, s[64:65]
    v_accvgpr_write_b32 a158, v218
    s_add_u32 m0, s73, 133120
    s_nop 0
    buffer_load_dwordx4 v7, s[16:19], s75 offen lds
    s_add_u32 s75, s75, s71
    v_mfma_f32_32x32x16_bf16 v[96:111], v[168:171], v[176:179], v[96:111]
    ds_read_b128 v[184:187], v11 offset:0
    v_add_f32 v212, v209, v208
    v_cos_f32 v213, v209
    v_mfma_f32_32x32x16_bf16 v[112:127], v[168:171], v[180:183], v[112:127]
    ds_read_b128 v[188:191], v11 offset:4096
    v_sin_f32 v214, -v209
    v_add_f32 v209, v212, v210
    s_add_u32 m0, s73, 117760
    s_nop 0
    buffer_load_dwordx4 v6, s[12:15], s75 offen lds
    v_mfma_f32_32x32x16_bf16 v[128:143], v[172:175], v[176:179], v[128:143]
    ds_read_b128 v[192:195], v11 offset:8192
    v_cos_f32 v215, v212
    v_sin_f32 v216, -v212
    v_mfma_f32_32x32x16_bf16 v[144:159], v[172:175], v[180:183], v[144:159]
    ds_read_b128 v[196:199], v11 offset:12288
    v_cvt_pk_bf16_f32 v217, v213, v215
    v_cvt_pk_bf16_f32 v218, v214, v216
    s_add_u32 m0, s73, 134144
    s_nop 0
    buffer_load_dwordx4 v7, s[16:19], s75 offen lds
    s_add_u32 s75, s75, s72
    s_cmp_ge_u32 s75, s37
    s_cselect_b32 s75, 0, s75
    s_cmp_ge_u32 s2, 224
    s_cbranch_scc1 W13D
    s_cmp_lt_u32 s4, 4
    s_cbranch_scc1 W18D
    s_waitcnt vmcnt(15)
    s_branch W18D
W13D:
    s_waitcnt vmcnt(13)
W18D:
    s_waitcnt vmcnt(18) lgkmcnt(0)
    s_barrier
    v_mfma_f32_32x32x16_bf16 v[32:47], v[184:187], v[200:203], v[32:47]
    ds_read_b64_tr_b16 v[176:177], v12 offset:32768
    v_accvgpr_write_b32 a155, v217
    v_cndmask_b32 v218, v218, v211, s[64:65]
    v_mfma_f32_32x32x16_bf16 v[48:63], v[184:187], v[204:207], v[48:63]
    ds_read_b64_tr_b16 v[178:179], v12 offset:33792
    v_accvgpr_write_b32 a159, v218
    v_fract_f32 v209, v209
    s_add_u32 m0, s73, 0
    s_nop 0
    buffer_load_dwordx4 v2, s[8:11], s74 offen lds
    v_mfma_f32_32x32x16_bf16 v[64:79], v[188:191], v[200:203], v[64:79]
    ds_read_b64_tr_b16 v[180:181], v12 offset:49152
    v_add_f32 v212, v209, v208
    v_cos_f32 v213, v209
    v_mfma_f32_32x32x16_bf16 v[80:95], v[188:191], v[204:207], v[80:95]
    ds_read_b64_tr_b16 v[182:183], v12 offset:50176
    v_sin_f32 v214, -v209
    v_add_f32 v209, v212, v208
    s_add_u32 m0, s73, 1024
    s_nop 0
    buffer_load_dwordx4 v3, s[8:11], s74 offen lds
    v_mfma_f32_32x32x16_bf16 v[96:111], v[192:195], v[200:203], v[96:111]
    ds_read_b128 v[160:163], v8 offset:16384
    v_cos_f32 v215, v212
    v_sin_f32 v216, -v212
    v_mfma_f32_32x32x16_bf16 v[112:127], v[192:195], v[204:207], v[112:127]
    ds_read_b128 v[164:167], v8 offset:20480
    v_cvt_pk_bf16_f32 v217, v213, v215
    v_cvt_pk_bf16_f32 v218, v214, v216
    s_add_u32 m0, s73, 2048
    s_nop 0
    buffer_load_dwordx4 v4, s[8:11], s74 offen lds
    v_mfma_f32_32x32x16_bf16 v[128:143], v[196:199], v[200:203], v[128:143]
    ds_read_b128 v[168:171], v8 offset:24576
    v_accvgpr_write_b32 a160, v217
    v_cndmask_b32 v218, v218, v211, s[64:65]
    v_mfma_f32_32x32x16_bf16 v[144:159], v[196:199], v[204:207], v[144:159]
    ds_read_b128 v[172:175], v8 offset:28672
    v_accvgpr_write_b32 a164, v218
    v_add_f32 v212, v209, v208
    s_add_u32 m0, s73, 3072
    s_nop 0
    buffer_load_dwordx4 v5, s[8:11], s74 offen lds
    s_add_u32 s74, s74, 128
    s_and_b32 s74, s74, 0x3ff
    s_waitcnt lgkmcnt(0)
    v_mfma_f32_32x32x16_bf16 v[32:47], v[160:163], v[176:179], v[32:47]
    ds_read_b64_tr_b16 v[200:201], v12 offset:36864
    v_cos_f32 v213, v209
    v_sin_f32 v214, -v209
    v_mfma_f32_32x32x16_bf16 v[48:63], v[160:163], v[180:183], v[48:63]
    ds_read_b64_tr_b16 v[202:203], v12 offset:37888
    v_add_f32 v209, v212, v208
    v_cos_f32 v215, v212
    s_add_u32 m0, s73, 49152
    s_nop 0
    buffer_load_dwordx4 v6, s[12:15], s75 offen lds
    v_mfma_f32_32x32x16_bf16 v[64:79], v[164:167], v[176:179], v[64:79]
    ds_read_b64_tr_b16 v[204:205], v12 offset:53248
    v_sin_f32 v216, -v212
    v_cvt_pk_bf16_f32 v217, v213, v215
    v_mfma_f32_32x32x16_bf16 v[80:95], v[164:167], v[180:183], v[80:95]
    ds_read_b64_tr_b16 v[206:207], v12 offset:54272
    v_cvt_pk_bf16_f32 v218, v214, v216
    v_accvgpr_write_b32 a161, v217
    s_add_u32 m0, s73, 65536
    s_nop 0
    buffer_load_dwordx4 v7, s[16:19], s75 offen lds
    s_add_u32 s75, s75, s71
    v_mfma_f32_32x32x16_bf16 v[96:111], v[168:171], v[176:179], v[96:111]
    ds_read_b128 v[184:187], v9 offset:16384
    v_cndmask_b32 v218, v218, v211, s[64:65]
    v_accvgpr_write_b32 a165, v218
    v_mfma_f32_32x32x16_bf16 v[112:127], v[168:171], v[180:183], v[112:127]
    ds_read_b128 v[188:191], v9 offset:20480
    v_add_f32 v212, v209, v208
    v_cos_f32 v213, v209
    s_add_u32 m0, s73, 50176
    s_nop 0
    buffer_load_dwordx4 v6, s[12:15], s75 offen lds
    v_mfma_f32_32x32x16_bf16 v[128:143], v[172:175], v[176:179], v[128:143]
    ds_read_b128 v[192:195], v9 offset:24576
    v_sin_f32 v214, -v209
    v_add_f32 v209, v212, v208
    v_mfma_f32_32x32x16_bf16 v[144:159], v[172:175], v[180:183], v[144:159]
    ds_read_b128 v[196:199], v9 offset:28672
    v_cos_f32 v215, v212
    v_sin_f32 v216, -v212
    s_add_u32 m0, s73, 66560
    s_nop 0
    buffer_load_dwordx4 v7, s[16:19], s75 offen lds
    s_add_u32 s75, s75, s71
    s_waitcnt lgkmcnt(0)
    v_mfma_f32_32x32x16_bf16 v[32:47], v[184:187], v[200:203], v[32:47]
    ds_read_b64_tr_b16 v[176:177], v12 offset:40960
    v_cvt_pk_bf16_f32 v217, v213, v215
    v_cvt_pk_bf16_f32 v218, v214, v216
    v_mfma_f32_32x32x16_bf16 v[48:63], v[184:187], v[204:207], v[48:63]
    ds_read_b64_tr_b16 v[178:179], v12 offset:41984
    v_accvgpr_write_b32 a162, v217
    v_cndmask_b32 v218, v218, v211, s[64:65]
    s_add_u32 m0, s73, 51200
    s_nop 0
    buffer_load_dwordx4 v6, s[12:15], s75 offen lds
    v_mfma_f32_32x32x16_bf16 v[64:79], v[188:191], v[200:203], v[64:79]
    ds_read_b64_tr_b16 v[180:181], v12 offset:57344
    v_accvgpr_write_b32 a166, v218
    v_add_f32 v212, v209, v208
    v_mfma_f32_32x32x16_bf16 v[80:95], v[188:191], v[204:207], v[80:95]
    ds_read_b64_tr_b16 v[182:183], v12 offset:58368
    v_cos_f32 v213, v209
    v_sin_f32 v214, -v209
    s_add_u32 m0, s73, 67584
    s_nop 0
    buffer_load_dwordx4 v7, s[16:19], s75 offen lds
    s_add_u32 s75, s75, s71
    v_mfma_f32_32x32x16_bf16 v[96:111], v[192:195], v[200:203], v[96:111]
    ds_read_b128 v[160:163], v10 offset:16384
    v_add_f32 v209, v212, v210
    v_cos_f32 v215, v212
    v_mfma_f32_32x32x16_bf16 v[112:127], v[192:195], v[204:207], v[112:127]
    ds_read_b128 v[164:167], v10 offset:20480
    v_sin_f32 v216, -v212
    v_cvt_pk_bf16_f32 v217, v213, v215
    s_add_u32 m0, s73, 52224
    s_nop 0
    buffer_load_dwordx4 v6, s[12:15], s75 offen lds
    v_mfma_f32_32x32x16_bf16 v[128:143], v[196:199], v[200:203], v[128:143]
    ds_read_b128 v[168:171], v10 offset:24576
    v_cvt_pk_bf16_f32 v218, v214, v216
    v_accvgpr_write_b32 a163, v217
    v_mfma_f32_32x32x16_bf16 v[144:159], v[196:199], v[204:207], v[144:159]
    ds_read_b128 v[172:175], v10 offset:28672
    v_cndmask_b32 v218, v218, v211, s[64:65]
    v_accvgpr_write_b32 a167, v218
    s_add_u32 m0, s73, 68608
    s_nop 0
    buffer_load_dwordx4 v7, s[16:19], s75 offen lds
    s_add_u32 s75, s75, s72
    s_cmp_ge_u32 s75, s37
    s_cselect_b32 s75, 0, s75
    s_waitcnt lgkmcnt(0)
    v_mfma_f32_32x32x16_bf16 v[32:47], v[160:163], v[176:179], v[32:47]
    ds_read_b64_tr_b16 v[200:201], v12 offset:45056
    v_fract_f32 v209, v209
    v_add_f32 v212, v209, v208
    v_mfma_f32_32x32x16_bf16 v[48:63], v[160:163], v[180:183], v[48:63]
    ds_read_b64_tr_b16 v[202:203], v12 offset:46080
    v_cos_f32 v213, v209
    v_sin_f32 v214, -v209
    v_mfma_f32_32x32x16_bf16 v[64:79], v[164:167], v[176:179], v[64:79]
    ds_read_b64_tr_b16 v[204:205], v12 offset:61440
    v_add_f32 v209, v212, v208
    v_cos_f32 v215, v212
    v_mfma_f32_32x32x16_bf16 v[80:95], v[164:167], v[180:183], v[80:95]
    ds_read_b64_tr_b16 v[206:207], v12 offset:62464
    v_sin_f32 v216, -v212
    v_cvt_pk_bf16_f32 v217, v213, v215
    v_mfma_f32_32x32x16_bf16 v[96:111], v[168:171], v[176:179], v[96:111]
    ds_read_b128 v[184:187], v11 offset:16384
    v_cvt_pk_bf16_f32 v218, v214, v216
    v_accvgpr_write_b32 a168, v217
    v_mfma_f32_32x32x16_bf16 v[112:127], v[168:171], v[180:183], v[112:127]
    ds_read_b128 v[188:191], v11 offset:20480
    v_cndmask_b32 v218, v218, v211, s[64:65]
    v_accvgpr_write_b32 a172, v218
    v_mfma_f32_32x32x16_bf16 v[128:143], v[172:175], v[176:179], v[128:143]
    ds_read_b128 v[192:195], v11 offset:24576
    v_add_f32 v212, v209, v208
    v_cos_f32 v213, v209
    v_mfma_f32_32x32x16_bf16 v[144:159], v[172:175], v[180:183], v[144:159]
    ds_read_b128 v[196:199], v11 offset:28672
    v_sin_f32 v214, -v209
    v_add_f32 v209, v212, v208
    s_waitcnt vmcnt(12) lgkmcnt(0)
    s_barrier
    s_cmp_eq_u32 s3, 0
    s_cbranch_scc0 NOARRD
    s_and_b32 s36, s2, 3
    s_lshl_b32 s36, s36, 6
    v_mov_b32 v15, 1
    s_mov_b64 exec, 1
    buffer_atomic_add v15, v248, s[28:31], s36 offen sc1
    s_mov_b64 exec, -1
NOARRD:
    v_mfma_f32_32x32x16_bf16 v[32:47], v[184:187], v[200:203], v[32:47]
    ds_read_b64_tr_b16 v[176:177], v13 offset:0
    v_cos_f32 v215, v212
    v_sin_f32 v216, -v212
    v_mfma_f32_32x32x16_bf16 v[48:63], v[184:187], v[204:207], v[48:63]
    ds_read_b64_tr_b16 v[178:179], v13 offset:1024
    v_cvt_pk_bf16_f32 v217, v213, v215
    v_cvt_pk_bf16_f32 v218, v214, v216
    s_add_u32 m0, s73, 16384
    s_nop 0
    buffer_load_dwordx4 v2, s[8:11], s74 offen lds
    v_mfma_f32_32x32x16_bf16 v[64:79], v[188:191], v[200:203], v[64:79]
    ds_read_b64_tr_b16 v[180:181], v13 offset:16384
    v_accvgpr_write_b32 a169, v217
    v_cndmask_b32 v218, v218, v211, s[64:65]
    v_mfma_f32_32x32x16_bf16 v[80:95], v[188:191], v[204:207], v[80:95]
    ds_read_b64_tr_b16 v[182:183], v13 offset:17408
    v_accvgpr_write_b32 a173, v218
    v_add_f32 v212, v209, v208
    s_add_u32 m0, s73, 17408
    s_nop 0
    buffer_load_dwordx4 v3, s[8:11], s74 offen lds
    v_mfma_f32_32x32x16_bf16 v[96:111], v[192:195], v[200:203], v[96:111]
    ds_read_b128 v[160:163], v8 offset:32768
    v_cos_f32 v213, v209
    v_sin_f32 v214, -v209
    v_mfma_f32_32x32x16_bf16 v[112:127], v[192:195], v[204:207], v[112:127]
    ds_read_b128 v[164:167], v8 offset:36864
    v_add_f32 v209, v212, v208
    v_cos_f32 v215, v212
    s_add_u32 m0, s73, 18432
    s_nop 0
    buffer_load_dwordx4 v4, s[8:11], s74 offen lds
    v_mfma_f32_32x32x16_bf16 v[128:143], v[196:199], v[200:203], v[128:143]
    ds_read_b128 v[168:171], v8 offset:40960
    v_sin_f32 v216, -v212
    v_cvt_pk_bf16_f32 v217, v213, v215
    v_mfma_f32_32x32x16_bf16 v[144:159], v[196:199], v[204:207], v[144:159]
    ds_read_b128 v[172:175], v8 offset:45056
    v_cvt_pk_bf16_f32 v218, v214, v216
    v_accvgpr_write_b32 a170, v217
    s_add_u32 m0, s73, 19456
    s_nop 0
    buffer_load_dwordx4 v5, s[8:11], s74 offen lds
    s_add_u32 s74, s74, 128
    s_and_b32 s74, s74, 0x3ff
    s_waitcnt lgkmcnt(0)
    v_mfma_f32_32x32x16_bf16 v[32:47], v[160:163], v[176:179], v[32:47]
    ds_read_b64_tr_b16 v[200:201], v13 offset:4096
    v_cndmask_b32 v218, v218, v211, s[64:65]
    v_accvgpr_write_b32 a174, v218
    v_mfma_f32_32x32x16_bf16 v[48:63], v[160:163], v[180:183], v[48:63]
    ds_read_b64_tr_b16 v[202:203], v13 offset:5120
    v_add_f32 v212, v209, v208
    v_cos_f32 v213, v209
    s_add_u32 m0, s73, 81920
    s_nop 0
    buffer_load_dwordx4 v6, s[12:15], s75 offen lds
    v_mfma_f32_32x32x16_bf16 v[64:79], v[164:167], v[176:179], v[64:79]
    ds_read_b64_tr_b16 v[204:205], v13 offset:20480
    v_sin_f32 v214, -v209
    v_add_f32 v209, v212, v210
    v_mfma_f32_32x32x16_bf16 v[80:95], v[164:167], v[180:183], v[80:95]
    ds_read_b64_tr_b16 v[206:207], v13 offset:21504
    v_cos_f32 v215, v212
    v_sin_f32 v216, -v212
    s_add_u32 m0, s73, 98304
    s_nop 0
    buffer_load_dwordx4 v7, s[16:19], s75 offen lds
    s_add_u32 s75, s75, s71
    v_mfma_f32_32x32x16_bf16 v[96:111], v[168:171], v[176:179], v[96:111]
    ds_read_b128 v[184:187], v9 offset:32768
    v_cvt_pk_bf16_f32 v217, v213, v215
    v_cvt_pk_bf16_f32 v218, v214, v216
    v_mfma_f32_32x32x16_bf16 v[112:127], v[168:171], v[180:183], v[112:127]
    ds_read_b128 v[188:191], v9 offset:36864
    v_accvgpr_write_b32 a171, v217
    v_cndmask_b32 v218, v218, v211, s[64:65]
    s_add_u32 m0, s73, 82944
    s_nop 0
    buffer_load_dwordx4 v6, s[12:15], s75 offen lds
    v_mfma_f32_32x32x16_bf16 v[128:143], v[172:175], v[176:179], v[128:143]
    ds_read_b128 v[192:195], v9 offset:40960
    v_accvgpr_write_b32 a175, v218
    v_fract_f32 v209, v209
    v_mfma_f32_32x32x16_bf16 v[144:159], v[172:175], v[180:183], v[144:159]
    ds_read_b128 v[196:199], v9 offset:45056
    v_add_f32 v212, v209, v208
    v_cos_f32 v213, v209
    s_add_u32 m0, s73, 99328
    s_nop 0
    buffer_load_dwordx4 v7, s[16:19], s75 offen lds
    s_add_u32 s75, s75, s71
    s_waitcnt lgkmcnt(0)
    v_mfma_f32_32x32x16_bf16 v[32:47], v[184:187], v[200:203], v[32:47]
    ds_read_b64_tr_b16 v[176:177], v13 offset:8192
    v_sin_f32 v214, -v209
    v_add_f32 v209, v212, v208
    v_mfma_f32_32x32x16_bf16 v[48:63], v[184:187], v[204:207], v[48:63]
    ds_read_b64_tr_b16 v[178:179], v13 offset:9216
    v_cos_f32 v215, v212
    v_sin_f32 v216, -v212
    s_add_u32 m0, s73, 83968
    s_nop 0
    buffer_load_dwordx4 v6, s[12:15], s75 offen lds
    v_mfma_f32_32x32x16_bf16 v[64:79], v[188:191], v[200:203], v[64:79]
    ds_read_b64_tr_b16 v[180:181], v13 offset:24576
    v_cvt_pk_bf16_f32 v217, v213, v215
    v_cvt_pk_bf16_f32 v218, v214, v216
    v_mfma_f32_32x32x16_bf16 v[80:95], v[188:191], v[204:207], v[80:95]
    ds_read_b64_tr_b16 v[182:183], v13 offset:25600
    v_accvgpr_write_b32 a176, v217
    v_cndmask_b32 v218, v218, v211, s[64:65]
    s_add_u32 m0, s73, 100352
    s_nop 0
    buffer_load_dwordx4 v7, s[16:19], s75 offen lds
    s_add_u32 s75, s75, s71
    v_mfma_f32_32x32x16_bf16 v[96:111], v[192:195], v[200:203], v[96:111]
    ds_read_b128 v[160:163], v10 offset:32768
    v_accvgpr_write_b32 a180, v218
    v_add_f32 v212, v209, v208
    v_mfma_f32_32x32x16_bf16 v[112:127], v[192:195], v[204:207], v[112:127]
    ds_read_b128 v[164:167], v10 offset:36864
    v_cos_f32 v213, v209
    v_sin_f32 v214, -v209
    s_add_u32 m0, s73, 84992
    s_nop 0
    buffer_load_dwordx4 v6, s[12:15], s75 offen lds
    v_mfma_f32_32x32x16_bf16 v[128:143], v[196:199], v[200:203], v[128:143]
    ds_read_b128 v[168:171], v10 offset:40960
    v_add_f32 v209, v212, v208
    v_cos_f32 v215, v212
    v_mfma_f32_32x32x16_bf16 v[144:159], v[196:199], v[204:207], v[144:159]
    ds_read_b128 v[172:175], v10 offset:45056
    v_sin_f32 v216, -v212
    v_cvt_pk_bf16_f32 v217, v213, v215
    s_add_u32 m0, s73, 101376
    s_nop 0
    buffer_load_dwordx4 v7, s[16:19], s75 offen lds
    s_add_u32 s75, s75, s72
    s_cmp_ge_u32 s75, s37
    s_cselect_b32 s75, 0, s75
    s_waitcnt lgkmcnt(0)
    v_mfma_f32_32x32x16_bf16 v[32:47], v[160:163], v[176:179], v[32:47]
    ds_read_b64_tr_b16 v[200:201], v13 offset:12288
    v_cvt_pk_bf16_f32 v218, v214, v216
    v_accvgpr_write_b32 a177, v217
    v_mfma_f32_32x32x16_bf16 v[48:63], v[160:163], v[180:183], v[48:63]
    ds_read_b64_tr_b16 v[202:203], v13 offset:13312
    v_cndmask_b32 v218, v218, v211, s[64:65]
    v_accvgpr_write_b32 a181, v218
    v_mfma_f32_32x32x16_bf16 v[64:79], v[164:167], v[176:179], v[64:79]
    ds_read_b64_tr_b16 v[204:205], v13 offset:28672
    v_add_f32 v212, v209, v208
    v_cos_f32 v213, v209
    v_mfma_f32_32x32x16_bf16 v[80:95], v[164:167], v[180:183], v[80:95]
    ds_read_b64_tr_b16 v[206:207], v13 offset:29696
    v_sin_f32 v214, -v209
    v_add_f32 v209, v212, v208
    v_mfma_f32_32x32x16_bf16 v[96:111], v[168:171], v[176:179], v[96:111]
    ds_read_b128 v[184:187], v11 offset:32768
    v_cos_f32 v215, v212
    v_sin_f32 v216, -v212
    v_mfma_f32_32x32x16_bf16 v[112:127], v[168:171], v[180:183], v[112:127]
    ds_read_b128 v[188:191], v11 offset:36864
    v_cvt_pk_bf16_f32 v217, v213, v215
    v_cvt_pk_bf16_f32 v218, v214, v216
    v_mfma_f32_32x32x16_bf16 v[128:143], v[172:175], v[176:179], v[128:143]
    ds_read_b128 v[192:195], v11 offset:40960
    v_accvgpr_write_b32 a178, v217
    v_cndmask_b32 v218, v218, v211, s[64:65]
    v_mfma_f32_32x32x16_bf16 v[144:159], v[172:175], v[180:183], v[144:159]
    ds_read_b128 v[196:199], v11 offset:45056
    v_accvgpr_write_b32 a182, v218
    v_add_f32 v212, v209, v208
    s_waitcnt vmcnt(12) lgkmcnt(0)
    s_barrier
    v_mfma_f32_32x32x16_bf16 v[32:47], v[184:187], v[200:203], v[32:47]
    ds_read_b64_tr_b16 v[176:177], v12 offset:0
    v_cos_f32 v213, v209
    v_sin_f32 v214, -v209
    v_mfma_f32_32x32x16_bf16 v[48:63], v[184:187], v[204:207], v[48:63]
    ds_read_b64_tr_b16 v[178:179], v12 offset:1024
    v_add_f32 v209, v212, v210
    v_cos_f32 v215, v212
    s_add_u32 m0, s73, 32768
    s_nop 0
    buffer_load_dwordx4 v2, s[8:11], s74 offen lds
    v_mfma_f32_32x32x16_bf16 v[64:79], v[188:191], v[200:203], v[64:79]
    ds_read_b64_tr_b16 v[180:181], v12 offset:16384
    v_sin_f32 v216, -v212
    v_cvt_pk_bf16_f32 v217, v213, v215
    v_mfma_f32_32x32x16_bf16 v[80:95], v[188:191], v[204:207], v[80:95]
    ds_read_b64_tr_b16 v[182:183], v12 offset:17408
    v_cvt_pk_bf16_f32 v218, v214, v216
    v_accvgpr_write_b32 a179, v217
    s_add_u32 m0, s73, 33792
    s_nop 0
    buffer_load_dwordx4 v3, s[8:11], s74 offen lds
    v_mfma_f32_32x32x16_bf16 v[96:111], v[192:195], v[200:203], v[96:111]
    ds_read_b128 v[160:163], v8 offset:0
    v_cndmask_b32 v218, v218, v211, s[64:65]
    v_accvgpr_write_b32 a183, v218
    v_mfma_f32_32x32x16_bf16 v[112:127], v[192:195], v[204:207], v[112:127]
    ds_read_b128 v[164:167], v8 offset:4096
    v_fract_f32 v209, v209
    v_add_f32 v212, v209, v208
    s_add_u32 m0, s73, 34816
    s_nop 0
    buffer_load_dwordx4 v4, s[8:11], s74 offen lds
    v_mfma_f32_32x32x16_bf16 v[128:143], v[196:199], v[200:203], v[128:143]
    ds_read_b128 v[168:171], v8 offset:8192
    v_cos_f32 v213, v209
    v_sin_f32 v214, -v209
    v_mfma_f32_32x32x16_bf16 v[144:159], v[196:199], v[204:207], v[144:159]
    ds_read_b128 v[172:175], v8 offset:12288
    v_add_f32 v209, v212, v208
    v_cos_f32 v215, v212
    s_add_u32 m0, s73, 35840
    s_nop 0
    buffer_load_dwordx4 v5, s[8:11], s74 offen lds
    s_add_u32 s74, s74, 128
    s_and_b32 s74, s74, 0x3ff
    s_waitcnt lgkmcnt(0)
    v_mfma_f32_32x32x16_bf16 v[32:47], v[160:163], v[176:179], v[32:47]
    ds_read_b64_tr_b16 v[200:201], v12 offset:4096
    v_sin_f32 v216, -v212
    v_cvt_pk_bf16_f32 v217, v213, v215
    v_mfma_f32_32x32x16_bf16 v[48:63], v[160:163], v[180:183], v[48:63]
    ds_read_b64_tr_b16 v[202:203], v12 offset:5120
    v_cvt_pk_bf16_f32 v218, v214, v216
    v_accvgpr_write_b32 a184, v217
    s_add_u32 m0, s73, 114688
    s_nop 0
    buffer_load_dwordx4 v6, s[12:15], s75 offen lds
    v_mfma_f32_32x32x16_bf16 v[64:79], v[164:167], v[176:179], v[64:79]
    ds_read_b64_tr_b16 v[204:205], v12 offset:20480
    v_cndmask_b32 v218, v218, v211, s[64:65]
    v_accvgpr_write_b32 a188, v218
    v_mfma_f32_32x32x16_bf16 v[80:95], v[164:167], v[180:183], v[80:95]
    ds_read_b64_tr_b16 v[206:207], v12 offset:21504
    v_add_f32 v212, v209, v208
    v_cos_f32 v213, v209
    s_add_u32 m0, s73, 131072
    s_nop 0
    buffer_load_dwordx4 v7, s[16:19], s75 offen lds
    s_add_u32 s75, s75, s71
    v_mfma_f32_32x32x16_bf16 v[96:111], v[168:171], v[176:179], v[96:111]
    ds_read_b128 v[184:187], v9 offset:0
    v_sin_f32 v214, -v209
    v_add_f32 v209, v212, v208
    v_mfma_f32_32x32x16_bf16 v[112:127], v[168:171], v[180:183], v[112:127]
    ds_read_b128 v[188:191], v9 offset:4096
    v_cos_f32 v215, v212
    v_sin_f32 v216, -v212
    s_add_u32 m0, s73, 115712
    s_nop 0
    buffer_load_dwordx4 v6, s[12:15], s75 offen lds
    v_mfma_f32_32x32x16_bf16 v[128:143], v[172:175], v[176:179], v[128:143]
    ds_read_b128 v[192:195], v9 offset:8192
    v_cvt_pk_bf16_f32 v217, v213, v215
    v_cvt_pk_bf16_f32 v218, v214, v216
    v_mfma_f32_32x32x16_bf16 v[144:159], v[172:175], v[180:183], v[144:159]
    ds_read_b128 v[196:199], v9 offset:12288
    v_accvgpr_write_b32 a185, v217
    v_cndmask_b32 v218, v218, v211, s[64:65]
    s_add_u32 m0, s73, 132096
    s_nop 0
    buffer_load_dwordx4 v7, s[16:19], s75 offen lds
    s_add_u32 s75, s75, s71
    s_waitcnt lgkmcnt(0)
    v_mfma_f32_32x32x16_bf16 v[32:47], v[184:187], v[200:203], v[32:47]
    ds_read_b64_tr_b16 v[176:177], v12 offset:8192
    v_accvgpr_write_b32 a189, v218
    v_add_f32 v212, v209, v208
    v_mfma_f32_32x32x16_bf16 v[48:63], v[184:187], v[204:207], v[48:63]
    ds_read_b64_tr_b16 v[178:179], v12 offset:9216
    v_cos_f32 v213, v209
    v_sin_f32 v214, -v209
    s_add_u32 m0, s73, 116736
    s_nop 0
    buffer_load_dwordx4 v6, s[12:15], s75 offen lds
    v_mfma_f32_32x32x16_bf16 v[64:79], v[188:191], v[200:203], v[64:79]
    ds_read_b64_tr_b16 v[180:181], v12 offset:24576
    v_add_f32 v209, v212, v208
    v_cos_f32 v215, v212
    v_mfma_f32_32x32x16_bf16 v[80:95], v[188:191], v[204:207], v[80:95]
    ds_read_b64_tr_b16 v[182:183], v12 offset:25600
    v_sin_f32 v216, -v212
    v_cvt_pk_bf16_f32 v217, v213, v215
    s_add_u32 m0, s73, 133120
    s_nop 0
    buffer_load_dwordx4 v7, s[16:19], s75 offen lds
    s_add_u32 s75, s75, s71
    v_mfma_f32_32x32x16_bf16 v[96:111], v[192:195], v[200:203], v[96:111]
    ds_read_b128 v[160:163], v10 offset:0
    v_cvt_pk_bf16_f32 v218, v214, v216
    v_accvgpr_write_b32 a186, v217
    v_mfma_f32_32x32x16_bf16 v[112:127], v[192:195], v[204:207], v[112:127]
    ds_read_b128 v[164:167], v10 offset:4096
    v_cndmask_b32 v218, v218, v211, s[64:65]
    v_accvgpr_write_b32 a190, v218
    s_add_u32 m0, s73, 117760
    s_nop 0
    buffer_load_dwordx4 v6, s[12:15], s75 offen lds
    v_mfma_f32_32x32x16_bf16 v[128:143], v[196:199], v[200:203], v[128:143]
    ds_read_b128 v[168:171], v10 offset:8192
    v_add_f32 v212, v209, v208
    v_cos_f32 v213, v209
    v_mfma_f32_32x32x16_bf16 v[144:159], v[196:199], v[204:207], v[144:159]
    ds_read_b128 v[172:175], v10 offset:12288
    v_sin_f32 v214, -v209
    v_add_f32 v209, v212, v210
    s_add_u32 m0, s73, 134144
    s_nop 0
    buffer_load_dwordx4 v7, s[16:19], s75 offen lds
    s_add_u32 s75, s75, s72
    s_cmp_ge_u32 s75, s37
    s_cselect_b32 s75, 0, s75
    s_waitcnt lgkmcnt(0)
    v_mfma_f32_32x32x16_bf16 v[32:47], v[160:163], v[176:179], v[32:47]
    ds_read_b64_tr_b16 v[200:201], v12 offset:12288
    v_cos_f32 v215, v212
    v_sin_f32 v216, -v212
    v_mfma_f32_32x32x16_bf16 v[48:63], v[160:163], v[180:183], v[48:63]
    ds_read_b64_tr_b16 v[202:203], v12 offset:13312
    v_cvt_pk_bf16_f32 v217, v213, v215
    v_cvt_pk_bf16_f32 v218, v214, v216
    v_mfma_f32_32x32x16_bf16 v[64:79], v[164:167], v[176:179], v[64:79]
    ds_read_b64_tr_b16 v[204:205], v12 offset:28672
    v_accvgpr_write_b32 a187, v217
    v_cndmask_b32 v218, v218, v211, s[64:65]
    v_mfma_f32_32x32x16_bf16 v[80:95], v[164:167], v[180:183], v[80:95]
    ds_read_b64_tr_b16 v[206:207], v12 offset:29696
    v_accvgpr_write_b32 a191, v218
    v_fract_f32 v209, v209
    v_mfma_f32_32x32x16_bf16 v[96:111], v[168:171], v[176:179], v[96:111]
    ds_read_b128 v[184:187], v11 offset:0
    v_add_f32 v212, v209, v208
    v_cos_f32 v213, v209
    v_mfma_f32_32x32x16_bf16 v[112:127], v[168:171], v[180:183], v[112:127]
    ds_read_b128 v[188:191], v11 offset:4096
    v_sin_f32 v214, -v209
    v_add_f32 v209, v212, v208
    v_mfma_f32_32x32x16_bf16 v[128:143], v[172:175], v[176:179], v[128:143]
    ds_read_b128 v[192:195], v11 offset:8192
    v_cos_f32 v215, v212
    v_sin_f32 v216, -v212
    v_mfma_f32_32x32x16_bf16 v[144:159], v[172:175], v[180:183], v[144:159]
    ds_read_b128 v[196:199], v11 offset:12288
    v_cvt_pk_bf16_f32 v217, v213, v215
    v_cvt_pk_bf16_f32 v218, v214, v216
    s_waitcnt vmcnt(12) lgkmcnt(0)
    s_barrier
    v_mfma_f32_32x32x16_bf16 v[32:47], v[184:187], v[200:203], v[32:47]
    ds_read_b64_tr_b16 v[176:177], v12 offset:32768
    v_accvgpr_write_b32 a192, v217
    v_cndmask_b32 v218, v218, v211, s[64:65]
    v_mfma_f32_32x32x16_bf16 v[48:63], v[184:187], v[204:207], v[48:63]
    ds_read_b64_tr_b16 v[178:179], v12 offset:33792
    v_accvgpr_write_b32 a196, v218
    v_add_f32 v212, v209, v208
    s_add_u32 m0, s73, 0
    s_nop 0
    buffer_load_dwordx4 v2, s[8:11], s74 offen lds
    v_mfma_f32_32x32x16_bf16 v[64:79], v[188:191], v[200:203], v[64:79]
    ds_read_b64_tr_b16 v[180:181], v12 offset:49152
    v_cos_f32 v213, v209
    v_sin_f32 v214, -v209
    v_mfma_f32_32x32x16_bf16 v[80:95], v[188:191], v[204:207], v[80:95]
    ds_read_b64_tr_b16 v[182:183], v12 offset:50176
    v_add_f32 v209, v212, v208
    v_cos_f32 v215, v212
    s_add_u32 m0, s73, 1024
    s_nop 0
    buffer_load_dwordx4 v3, s[8:11], s74 offen lds
    v_mfma_f32_32x32x16_bf16 v[96:111], v[192:195], v[200:203], v[96:111]
    ds_read_b128 v[160:163], v8 offset:16384
    v_sin_f32 v216, -v212
    v_cvt_pk_bf16_f32 v217, v213, v215
    v_mfma_f32_32x32x16_bf16 v[112:127], v[192:195], v[204:207], v[112:127]
    ds_read_b128 v[164:167], v8 offset:20480
    v_cvt_pk_bf16_f32 v218, v214, v216
    v_accvgpr_write_b32 a193, v217
    s_add_u32 m0, s73, 2048
    s_nop 0
    buffer_load_dwordx4 v4, s[8:11], s74 offen lds
    v_mfma_f32_32x32x16_bf16 v[128:143], v[196:199], v[200:203], v[128:143]
    ds_read_b128 v[168:171], v8 offset:24576
    v_cndmask_b32 v218, v218, v211, s[64:65]
    v_accvgpr_write_b32 a197, v218
    v_mfma_f32_32x32x16_bf16 v[144:159], v[196:199], v[204:207], v[144:159]
    ds_read_b128 v[172:175], v8 offset:28672
    v_add_f32 v212, v209, v208
    v_cos_f32 v213, v209
    s_add_u32 m0, s73, 3072
    s_nop 0
    buffer_load_dwordx4 v5, s[8:11], s74 offen lds
    s_add_u32 s74, s74, 128
    s_and_b32 s74, s74, 0x3ff
    s_waitcnt lgkmcnt(0)
    v_mfma_f32_32x32x16_bf16 v[32:47], v[160:163], v[176:179], v[32:47]
    ds_read_b64_tr_b16 v[200:201], v12 offset:36864
    v_sin_f32 v214, -v209
    v_add_f32 v209, v212, v208
    v_mfma_f32_32x32x16_bf16 v[48:63], v[160:163], v[180:183], v[48:63]
    ds_read_b64_tr_b16 v[202:203], v12 offset:37888
    v_cos_f32 v215, v212
    v_sin_f32 v216, -v212
    s_add_u32 m0, s73, 49152
    s_nop 0
    buffer_load_dwordx4 v6, s[12:15], s75 offen lds
    v_mfma_f32_32x32x16_bf16 v[64:79], v[164:167], v[176:179], v[64:79]
    ds_read_b64_tr_b16 v[204:205], v12 offset:53248
    v_cvt_pk_bf16_f32 v217, v213, v215
    v_cvt_pk_bf16_f32 v218, v214, v216
    v_mfma_f32_32x32x16_bf16 v[80:95], v[164:167], v[180:183], v[80:95]
    ds_read_b64_tr_b16 v[206:207], v12 offset:54272
    v_accvgpr_write_b32 a194, v217
    v_cndmask_b32 v218, v218, v211, s[64:65]
    s_add_u32 m0, s73, 65536
    s_nop 0
    buffer_load_dwordx4 v7, s[16:19], s75 offen lds
    s_add_u32 s75, s75, s71
    v_mfma_f32_32x32x16_bf16 v[96:111], v[168:171], v[176:179], v[96:111]
    ds_read_b128 v[184:187], v9 offset:16384
    v_accvgpr_write_b32 a198, v218
    v_add_f32 v212, v209, v208
    v_mfma_f32_32x32x16_bf16 v[112:127], v[168:171], v[180:183], v[112:127]
    ds_read_b128 v[188:191], v9 offset:20480
    v_cos_f32 v213, v209
    v_sin_f32 v214, -v209
    s_add_u32 m0, s73, 50176
    s_nop 0
    buffer_load_dwordx4 v6, s[12:15], s75 offen lds
    v_mfma_f32_32x32x16_bf16 v[128:143], v[172:175], v[176:179], v[128:143]
    ds_read_b128 v[192:195], v9 offset:24576
    v_add_f32 v209, v212, v210
    v_cos_f32 v215, v212
    v_mfma_f32_32x32x16_bf16 v[144:159], v[172:175], v[180:183], v[144:159]
    ds_read_b128 v[196:199], v9 offset:28672
    v_sin_f32 v216, -v212
    v_cvt_pk_bf16_f32 v217, v213, v215
    s_add_u32 m0, s73, 66560
    s_nop 0
    buffer_load_dwordx4 v7, s[16:19], s75 offen lds
    s_add_u32 s75, s75, s71
    s_waitcnt lgkmcnt(0)
    v_mfma_f32_32x32x16_bf16 v[32:47], v[184:187], v[200:203], v[32:47]
    ds_read_b64_tr_b16 v[176:177], v12 offset:40960
    v_cvt_pk_bf16_f32 v218, v214, v216
    v_accvgpr_write_b32 a195, v217
    v_mfma_f32_32x32x16_bf16 v[48:63], v[184:187], v[204:207], v[48:63]
    ds_read_b64_tr_b16 v[178:179], v12 offset:41984
    v_cndmask_b32 v218, v218, v211, s[64:65]
    v_accvgpr_write_b32 a199, v218
    s_add_u32 m0, s73, 51200
    s_nop 0
    buffer_load_dwordx4 v6, s[12:15], s75 offen lds
    v_mfma_f32_32x32x16_bf16 v[64:79], v[188:191], v[200:203], v[64:79]
    ds_read_b64_tr_b16 v[180:181], v12 offset:57344
    v_fract_f32 v209, v209
    v_add_f32 v212, v209, v208
    v_mfma_f32_32x32x16_bf16 v[80:95], v[188:191], v[204:207], v[80:95]
    ds_read_b64_tr_b16 v[182:183], v12 offset:58368
    v_cos_f32 v213, v209
    v_sin_f32 v214, -v209
    s_add_u32 m0, s73, 67584
    s_nop 0
    buffer_load_dwordx4 v7, s[16:19], s75 offen lds
    s_add_u32 s75, s75, s71
    v_mfma_f32_32x32x16_bf16 v[96:111], v[192:195], v[200:203], v[96:111]
    ds_read_b128 v[160:163], v10 offset:16384
    v_add_f32 v209, v212, v208
    v_cos_f32 v215, v212
    v_mfma_f32_32x32x16_bf16 v[112:127], v[192:195], v[204:207], v[112:127]
    ds_read_b128 v[164:167], v10 offset:20480
    v_sin_f32 v216, -v212
    v_cvt_pk_bf16_f32 v217, v213, v215
    s_add_u32 m0, s73, 52224
    s_nop 0
    buffer_load_dwordx4 v6, s[12:15], s75 offen lds
    v_mfma_f32_32x32x16_bf16 v[128:143], v[196:199], v[200:203], v[128:143]
    ds_read_b128 v[168:171], v10 offset:24576
    v_cvt_pk_bf16_f32 v218, v214, v216
    v_accvgpr_write_b32 a200, v217
    v_mfma_f32_32x32x16_bf16 v[144:159], v[196:199], v[204:207], v[144:159]
    ds_read_b128 v[172:175], v10 offset:28672
    v_cndmask_b32 v218, v218, v211, s[64:65]
    v_accvgpr_write_b32 a204, v218
    s_add_u32 m0, s73, 68608
    s_nop 0
    buffer_load_dwordx4 v7, s[16:19], s75 offen lds
    s_add_u32 s75, s75, s72
    s_cmp_ge_u32 s75, s37
    s_cselect_b32 s75, 0, s75
    s_waitcnt lgkmcnt(0)
    v_mfma_f32_32x32x16_bf16 v[32:47], v[160:163], v[176:179], v[32:47]
    ds_read_b64_tr_b16 v[200:201], v12 offset:45056
    v_add_f32 v212, v209, v208
    v_cos_f32 v213, v209
    v_mfma_f32_32x32x16_bf16 v[48:63], v[160:163], v[180:183], v[48:63]
    ds_read_b64_tr_b16 v[202:203], v12 offset:46080
    v_sin_f32 v214, -v209
    v_add_f32 v209, v212, v208
    v_mfma_f32_32x32x16_bf16 v[64:79], v[164:167], v[176:179], v[64:79]
    ds_read_b64_tr_b16 v[204:205], v12 offset:61440
    v_cos_f32 v215, v212
    v_sin_f32 v216, -v212
    v_mfma_f32_32x32x16_bf16 v[80:95], v[164:167], v[180:183], v[80:95]
    ds_read_b64_tr_b16 v[206:207], v12 offset:62464
    v_cvt_pk_bf16_f32 v217, v213, v215
    v_cvt_pk_bf16_f32 v218, v214, v216
    v_mfma_f32_32x32x16_bf16 v[96:111], v[168:171], v[176:179], v[96:111]
    ds_read_b128 v[184:187], v11 offset:16384
    v_accvgpr_write_b32 a201, v217
    v_cndmask_b32 v218, v218, v211, s[64:65]
    v_mfma_f32_32x32x16_bf16 v[112:127], v[168:171], v[180:183], v[112:127]
    ds_read_b128 v[188:191], v11 offset:20480
    v_accvgpr_write_b32 a205, v218
    v_add_f32 v212, v209, v208
    v_mfma_f32_32x32x16_bf16 v[128:143], v[172:175], v[176:179], v[128:143]
    ds_read_b128 v[192:195], v11 offset:24576
    v_cos_f32 v213, v209
    v_sin_f32 v214, -v209
    v_mfma_f32_32x32x16_bf16 v[144:159], v[172:175], v[180:183], v[144:159]
    ds_read_b128 v[196:199], v11 offset:28672
    v_add_f32 v209, v212, v208
    v_cos_f32 v215, v212
    s_waitcnt vmcnt(12) lgkmcnt(0)
    s_barrier
    buffer_load_dword v15, v14, s[28:31], 0 offen sc1
    v_mfma_f32_32x32x16_bf16 v[32:47], v[184:187], v[200:203], v[32:47]
    ds_read_b64_tr_b16 v[176:177], v13 offset:0
    v_sin_f32 v216, -v212
    v_cvt_pk_bf16_f32 v217, v213, v215
    v_mfma_f32_32x32x16_bf16 v[48:63], v[184:187], v[204:207], v[48:63]
    ds_read_b64_tr_b16 v[178:179], v13 offset:1024
    v_cvt_pk_bf16_f32 v218, v214, v216
    v_accvgpr_write_b32 a202, v217
    s_add_u32 m0, s73, 16384
    s_nop 0
    buffer_load_dwordx4 v2, s[8:11], s74 offen lds
    v_mfma_f32_32x32x16_bf16 v[64:79], v[188:191], v[200:203], v[64:79]
    ds_read_b64_tr_b16 v[180:181], v13 offset:16384
    v_cndmask_b32 v218, v218, v211, s[64:65]
    v_accvgpr_write_b32 a206, v218
    v_mfma_f32_32x32x16_bf16 v[80:95], v[188:191], v[204:207], v[80:95]
    ds_read_b64_tr_b16 v[182:183], v13 offset:17408
    v_add_f32 v212, v209, v208
    v_cos_f32 v213, v209
    s_add_u32 m0, s73, 17408
    s_nop 0
    buffer_load_dwordx4 v3, s[8:11], s74 offen lds
    v_mfma_f32_32x32x16_bf16 v[96:111], v[192:195], v[200:203], v[96:111]
    ds_read_b128 v[160:163], v8 offset:32768
    v_sin_f32 v214, -v209
    v_add_f32 v209, v212, v210
    v_mfma_f32_32x32x16_bf16 v[112:127], v[192:195], v[204:207], v[112:127]
    ds_read_b128 v[164:167], v8 offset:36864
    v_cos_f32 v215, v212
    v_sin_f32 v216, -v212
    s_add_u32 m0, s73, 18432
    s_nop 0
    buffer_load_dwordx4 v4, s[8:11], s74 offen lds
    v_mfma_f32_32x32x16_bf16 v[128:143], v[196:199], v[200:203], v[128:143]
    ds_read_b128 v[168:171], v8 offset:40960
    v_cvt_pk_bf16_f32 v217, v213, v215
    v_cvt_pk_bf16_f32 v218, v214, v216
    v_mfma_f32_32x32x16_bf16 v[144:159], v[196:199], v[204:207], v[144:159]
    ds_read_b128 v[172:175], v8 offset:45056
    v_accvgpr_write_b32 a203, v217
    v_cndmask_b32 v218, v218, v211, s[64:65]
    s_add_u32 m0, s73, 19456
    s_nop 0
    buffer_load_dwordx4 v5, s[8:11], s74 offen lds
    s_add_u32 s74, s74, 128
    s_and_b32 s74, s74, 0x3ff
    s_waitcnt lgkmcnt(0)
    v_mfma_f32_32x32x16_bf16 v[32:47], v[160:163], v[176:179], v[32:47]
    ds_read_b64_tr_b16 v[200:201], v13 offset:4096
    v_accvgpr_write_b32 a207, v218
    v_fract_f32 v209, v209
    v_mfma_f32_32x32x16_bf16 v[48:63], v[160:163], v[180:183], v[48:63]
    ds_read_b64_tr_b16 v[202:203], v13 offset:5120
    v_add_f32 v212, v209, v208
    v_cos_f32 v213, v209
    s_add_u32 m0, s73, 81920
    s_nop 0
    buffer_load_dwordx4 v6, s[12:15], s75 offen lds
    v_mfma_f32_32x32x16_bf16 v[64:79], v[164:167], v[176:179], v[64:79]
    ds_read_b64_tr_b16 v[204:205], v13 offset:20480
    v_sin_f32 v214, -v209
    v_add_f32 v209, v212, v208
    v_mfma_f32_32x32x16_bf16 v[80:95], v[164:167], v[180:183], v[80:95]
    ds_read_b64_tr_b16 v[206:207], v13 offset:21504
    v_cos_f32 v215, v212
    v_sin_f32 v216, -v212
    s_add_u32 m0, s73, 98304
    s_nop 0
    buffer_load_dwordx4 v7, s[16:19], s75 offen lds
    s_add_u32 s75, s75, s71
    v_mfma_f32_32x32x16_bf16 v[96:111], v[168:171], v[176:179], v[96:111]
    ds_read_b128 v[184:187], v9 offset:32768
    v_cvt_pk_bf16_f32 v217, v213, v215
    v_cvt_pk_bf16_f32 v218, v214, v216
    v_mfma_f32_32x32x16_bf16 v[112:127], v[168:171], v[180:183], v[112:127]
    ds_read_b128 v[188:191], v9 offset:36864
    v_accvgpr_write_b32 a208, v217
    v_cndmask_b32 v218, v218, v211, s[64:65]
    s_add_u32 m0, s73, 82944
    s_nop 0
    buffer_load_dwordx4 v6, s[12:15], s75 offen lds
    v_mfma_f32_32x32x16_bf16 v[128:143], v[172:175], v[176:179], v[128:143]
    ds_read_b128 v[192:195], v9 offset:40960
    v_accvgpr_write_b32 a212, v218
    v_add_f32 v212, v209, v208
    v_mfma_f32_32x32x16_bf16 v[144:159], v[172:175], v[180:183], v[144:159]
    ds_read_b128 v[196:199], v9 offset:45056
    v_cos_f32 v213, v209
    v_sin_f32 v214, -v209
    s_add_u32 m0, s73, 99328
    s_nop 0
    buffer_load_dwordx4 v7, s[16:19], s75 offen lds
    s_add_u32 s75, s75, s71
    s_waitcnt lgkmcnt(0)
    v_mfma_f32_32x32x16_bf16 v[32:47], v[184:187], v[200:203], v[32:47]
    ds_read_b64_tr_b16 v[176:177], v13 offset:8192
    v_add_f32 v209, v212, v208
    v_cos_f32 v215, v212
    v_mfma_f32_32x32x16_bf16 v[48:63], v[184:187], v[204:207], v[48:63]
    ds_read_b64_tr_b16 v[178:179], v13 offset:9216
    v_sin_f32 v216, -v212
    v_cvt_pk_bf16_f32 v217, v213, v215
    s_add_u32 m0, s73, 83968
    s_nop 0
    buffer_load_dwordx4 v6, s[12:15], s75 offen lds
    v_mfma_f32_32x32x16_bf16 v[64:79], v[188:191], v[200:203], v[64:79]
    ds_read_b64_tr_b16 v[180:181], v13 offset:24576
    v_cvt_pk_bf16_f32 v218, v214, v216
    v_accvgpr_write_b32 a209, v217
    v_mfma_f32_32x32x16_bf16 v[80:95], v[188:191], v[204:207], v[80:95]
    ds_read_b64_tr_b16 v[182:183], v13 offset:25600
    v_cndmask_b32 v218, v218, v211, s[64:65]
    v_accvgpr_write_b32 a213, v218
    s_add_u32 m0, s73, 100352
    s_nop 0
    buffer_load_dwordx4 v7, s[16:19], s75 offen lds
    s_add_u32 s75, s75, s71
    v_mfma_f32_32x32x16_bf16 v[96:111], v[192:195], v[200:203], v[96:111]
    ds_read_b128 v[160:163], v10 offset:32768
    v_add_f32 v212, v209, v208
    v_cos_f32 v213, v209
    v_mfma_f32_32x32x16_bf16 v[112:127], v[192:195], v[204:207], v[112:127]
    ds_read_b128 v[164:167], v10 offset:36864
    v_sin_f32 v214, -v209
    v_add_f32 v209, v212, v208
    s_add_u32 m0, s73, 84992
    s_nop 0
    buffer_load_dwordx4 v6, s[12:15], s75 offen lds
    v_mfma_f32_32x32x16_bf16 v[128:143], v[196:199], v[200:203], v[128:143]
    ds_read_b128 v[168:171], v10 offset:40960
    v_cos_f32 v215, v212
    v_sin_f32 v216, -v212
    v_mfma_f32_32x32x16_bf16 v[144:159], v[196:199], v[204:207], v[144:159]
    ds_read_b128 v[172:175], v10 offset:45056
    v_cvt_pk_bf16_f32 v217, v213, v215
    v_cvt_pk_bf16_f32 v218, v214, v216
    s_add_u32 m0, s73, 101376
    s_nop 0
    buffer_load_dwordx4 v7, s[16:19], s75 offen lds
    s_add_u32 s75, s75, s72
    s_cmp_ge_u32 s75, s37
    s_cselect_b32 s75, 0, s75
    s_waitcnt lgkmcnt(0)
    v_mfma_f32_32x32x16_bf16 v[32:47], v[160:163], v[176:179], v[32:47]
    ds_read_b64_tr_b16 v[200:201], v13 offset:12288
    v_accvgpr_write_b32 a210, v217
    v_cndmask_b32 v218, v218, v211, s[64:65]
    v_mfma_f32_32x32x16_bf16 v[48:63], v[160:163], v[180:183], v[48:63]
    ds_read_b64_tr_b16 v[202:203], v13 offset:13312
    v_accvgpr_write_b32 a214, v218
    v_add_f32 v212, v209, v208
    v_mfma_f32_32x32x16_bf16 v[64:79], v[164:167], v[176:179], v[64:79]
    ds_read_b64_tr_b16 v[204:205], v13 offset:28672
    v_cos_f32 v213, v209
    v_sin_f32 v214, -v209
    v_mfma_f32_32x32x16_bf16 v[80:95], v[164:167], v[180:183], v[80:95]
    ds_read_b64_tr_b16 v[206:207], v13 offset:29696
    v_add_f32 v209, v212, v210
    v_cos_f32 v215, v212
    v_mfma_f32_32x32x16_bf16 v[96:111], v[168:171], v[176:179], v[96:111]
    ds_read_b128 v[184:187], v11 offset:32768
    v_sin_f32 v216, -v212
    v_cvt_pk_bf16_f32 v217, v213, v215
    v_mfma_f32_32x32x16_bf16 v[112:127], v[168:171], v[180:183], v[112:127]
    ds_read_b128 v[188:191], v11 offset:36864
    v_cvt_pk_bf16_f32 v218, v214, v216
    v_accvgpr_write_b32 a211, v217
    v_mfma_f32_32x32x16_bf16 v[128:143], v[172:175], v[176:179], v[128:143]
    ds_read_b128 v[192:195], v11 offset:40960
    v_cndmask_b32 v218, v218, v211, s[64:65]
    v_accvgpr_write_b32 a215, v218
    v_mfma_f32_32x32x16_bf16 v[144:159], v[172:175], v[180:183], v[144:159]
    ds_read_b128 v[196:199], v11 offset:45056
    v_fract_f32 v209, v209
    v_add_f32 v212, v209, v208
    s_waitcnt vmcnt(12) lgkmcnt(0)
    s_barrier
    s_mov_b32 s36, 0
C0CHKD:
    v_cmp_gt_u32 vcc, 64, v15
    s_cbranch_vccz C0OKD
    s_sleep 2
    buffer_load_dword v15, v14, s[28:31], 0 offen sc1
    s_add_u32 s36, s36, 1
    s_waitcnt vmcnt(0)
    s_cmp_lt_u32 s36, 0x40000
    s_cbranch_scc1 C0CHKD
C0OKD:
    v_mfma_f32_32x32x16_bf16 v[32:47], v[184:187], v[200:203], v[32:47]
    ds_read_b64_tr_b16 v[176:177], v12 offset:0
    v_cos_f32 v213, v209
    v_sin_f32 v214, -v209
    v_mfma_f32_32x32x16_bf16 v[48:63], v[184:187], v[204:207], v[48:63]
    ds_read_b64_tr_b16 v[178:179], v12 offset:1024
    v_add_f32 v209, v212, v208
    v_cos_f32 v215, v212
    buffer_load_dword v20, v16, s[20:23], s82 offen offset:0 sc1
    v_mfma_f32_32x32x16_bf16 v[64:79], v[188:191], v[200:203], v[64:79]
    ds_read_b64_tr_b16 v[180:181], v12 offset:16384
    v_sin_f32 v216, -v212
    v_cvt_pk_bf16_f32 v217, v213, v215
    v_mfma_f32_32x32x16_bf16 v[80:95], v[188:191], v[204:207], v[80:95]
    ds_read_b64_tr_b16 v[182:183], v12 offset:17408
    v_cvt_pk_bf16_f32 v218, v214, v216
    v_accvgpr_write_b32 a216, v217
    buffer_load_dword v21, v16, s[20:23], s82 offen offset:128 sc1
    v_mfma_f32_32x32x16_bf16 v[96:111], v[192:195], v[200:203], v[96:111]
    ds_read_b128 v[160:163], v8 offset:0
    v_cndmask_b32 v218, v218, v211, s[64:65]
    v_accvgpr_write_b32 a220, v218
    v_mfma_f32_32x32x16_bf16 v[112:127], v[192:195], v[204:207], v[112:127]
    ds_read_b128 v[164:167], v8 offset:4096
    v_add_f32 v212, v209, v208
    v_cos_f32 v213, v209
    buffer_load_dword v22, v16, s[20:23], s82 offen offset:256 sc1
    v_mfma_f32_32x32x16_bf16 v[128:143], v[196:199], v[200:203], v[128:143]
    ds_read_b128 v[168:171], v8 offset:8192
    v_sin_f32 v214, -v209
    v_add_f32 v209, v212, v208
    v_mfma_f32_32x32x16_bf16 v[144:159], v[196:199], v[204:207], v[144:159]
    ds_read_b128 v[172:175], v8 offset:12288
    v_cos_f32 v215, v212
    v_sin_f32 v216, -v212
    buffer_load_dword v23, v16, s[20:23], s82 offen offset:384 sc1
    s_waitcnt lgkmcnt(0)
    v_mfma_f32_32x32x16_bf16 v[32:47], v[160:163], v[176:179], v[32:47]
    ds_read_b64_tr_b16 v[200:201], v12 offset:4096
    v_cvt_pk_bf16_f32 v217, v213, v215
    v_cvt_pk_bf16_f32 v218, v214, v216
    v_mfma_f32_32x32x16_bf16 v[48:63], v[160:163], v[180:183], v[48:63]
    ds_read_b64_tr_b16 v[202:203], v12 offset:5120
    v_accvgpr_write_b32 a217, v217
    v_cndmask_b32 v218, v218, v211, s[64:65]
    buffer_load_dwordx4 v[224:227], v17, s[20:23], s83 offen offset:0 sc1
    v_mfma_f32_32x32x16_bf16 v[64:79], v[164:167], v[176:179], v[64:79]
    ds_read_b64_tr_b16 v[204:205], v12 offset:20480
    v_accvgpr_write_b32 a221, v218
    v_add_f32 v212, v209, v208
    v_mfma_f32_32x32x16_bf16 v[80:95], v[164:167], v[180:183], v[80:95]
    ds_read_b64_tr_b16 v[206:207], v12 offset:21504
    v_cos_f32 v213, v209
    v_sin_f32 v214, -v209
    buffer_load_dwordx4 v[228:231], v17, s[20:23], s83 offen offset:32 sc1
    v_mfma_f32_32x32x16_bf16 v[96:111], v[168:171], v[176:179], v[96:111]
    ds_read_b128 v[184:187], v9 offset:0
    v_add_f32 v209, v212, v208
    v_cos_f32 v215, v212
    v_mfma_f32_32x32x16_bf16 v[112:127], v[168:171], v[180:183], v[112:127]
    ds_read_b128 v[188:191], v9 offset:4096
    v_sin_f32 v216, -v212
    v_cvt_pk_bf16_f32 v217, v213, v215
    buffer_load_dwordx4 v[232:235], v17, s[20:23], s83 offen offset:64 sc1
    v_mfma_f32_32x32x16_bf16 v[128:143], v[172:175], v[176:179], v[128:143]
    ds_read_b128 v[192:195], v9 offset:8192
    v_cvt_pk_bf16_f32 v218, v214, v216
    v_accvgpr_write_b32 a218, v217
    v_mfma_f32_32x32x16_bf16 v[144:159], v[172:175], v[180:183], v[144:159]
    ds_read_b128 v[196:199], v9 offset:12288
    v_cndmask_b32 v218, v218, v211, s[64:65]
    v_accvgpr_write_b32 a222, v218
    buffer_load_dwordx4 v[236:239], v17, s[20:23], s83 offen offset:96 sc1
    s_waitcnt lgkmcnt(0)
    v_mfma_f32_32x32x16_bf16 v[32:47], v[184:187], v[200:203], v[32:47]
    ds_read_b64_tr_b16 v[176:177], v12 offset:8192
    v_add_f32 v212, v209, v208
    v_cos_f32 v213, v209
    v_mfma_f32_32x32x16_bf16 v[48:63], v[184:187], v[204:207], v[48:63]
    ds_read_b64_tr_b16 v[178:179], v12 offset:9216
    v_sin_f32 v214, -v209
    v_add_f32 v209, v212, v210
    buffer_load_dwordx4 v[240:243], v17, s[20:23], s83 offen offset:128 sc1
    v_mfma_f32_32x32x16_bf16 v[64:79], v[188:191], v[200:203], v[64:79]
    ds_read_b64_tr_b16 v[180:181], v12 offset:24576
    v_cos_f32 v215, v212
    v_sin_f32 v216, -v212
    v_mfma_f32_32x32x16_bf16 v[80:95], v[188:191], v[204:207], v[80:95]
    ds_read_b64_tr_b16 v[182:183], v12 offset:25600
    v_cvt_pk_bf16_f32 v217, v213, v215
    v_cvt_pk_bf16_f32 v218, v214, v216
    buffer_load_dwordx4 v[244:247], v17, s[20:23], s83 offen offset:160 sc1
    v_mfma_f32_32x32x16_bf16 v[96:111], v[192:195], v[200:203], v[96:111]
    ds_read_b128 v[160:163], v10 offset:0
    v_accvgpr_write_b32 a219, v217
    v_cndmask_b32 v218, v218, v211, s[64:65]
    v_mfma_f32_32x32x16_bf16 v[112:127], v[192:195], v[204:207], v[112:127]
    ds_read_b128 v[164:167], v10 offset:4096
    v_accvgpr_write_b32 a223, v218
    buffer_load_dwordx4 v[248:251], v17, s[20:23], s83 offen offset:192 sc1
    v_mfma_f32_32x32x16_bf16 v[128:143], v[196:199], v[200:203], v[128:143]
    ds_read_b128 v[168:171], v10 offset:8192
    v_mfma_f32_32x32x16_bf16 v[144:159], v[196:199], v[204:207], v[144:159]
    ds_read_b128 v[172:175], v10 offset:12288
    buffer_load_dwordx4 v[252:255], v17, s[20:23], s83 offen offset:224 sc1
    s_waitcnt lgkmcnt(0)
    v_mfma_f32_32x32x16_bf16 v[32:47], v[160:163], v[176:179], v[32:47]
    ds_read_b64_tr_b16 v[200:201], v12 offset:12288
    v_mfma_f32_32x32x16_bf16 v[48:63], v[160:163], v[180:183], v[48:63]
    ds_read_b64_tr_b16 v[202:203], v12 offset:13312
    buffer_load_dwordx4 a[0:3], v1, s[20:23], s81 offen offset:0 sc1
    v_mfma_f32_32x32x16_bf16 v[64:79], v[164:167], v[176:179], v[64:79]
    ds_read_b64_tr_b16 v[204:205], v12 offset:28672
    v_mfma_f32_32x32x16_bf16 v[80:95], v[164:167], v[180:183], v[80:95]
    ds_read_b64_tr_b16 v[206:207], v12 offset:29696
    buffer_load_dwordx4 a[4:7], v1, s[20:23], s81 offen offset:1024 sc1
    v_mfma_f32_32x32x16_bf16 v[96:111], v[168:171], v[176:179], v[96:111]
    ds_read_b128 v[184:187], v11 offset:0
    v_mfma_f32_32x32x16_bf16 v[112:127], v[168:171], v[180:183], v[112:127]
    ds_read_b128 v[188:191], v11 offset:4096
    buffer_load_dwordx4 a[8:11], v1, s[20:23], s81 offen offset:2048 sc1
    v_mfma_f32_32x32x16_bf16 v[128:143], v[172:175], v[176:179], v[128:143]
    ds_read_b128 v[192:195], v11 offset:8192
    v_mfma_f32_32x32x16_bf16 v[144:159], v[172:175], v[180:183], v[144:159]
    ds_read_b128 v[196:199], v11 offset:12288
    buffer_load_dwordx4 a[12:15], v1, s[20:23], s81 offen offset:3072 sc1
    s_add_u32 s81, s81, 4096
    s_cmp_ge_u32 s81, s47
    s_cselect_b32 s81, s46, s81
    s_waitcnt vmcnt(16) lgkmcnt(0)
    s_barrier
    v_mfma_f32_32x32x16_bf16 v[32:47], v[184:187], v[200:203], v[32:47]
    ds_read_b64_tr_b16 v[176:177], v12 offset:32768
    v_mfma_f32_32x32x16_bf16 v[48:63], v[184:187], v[204:207], v[48:63]
    ds_read_b64_tr_b16 v[178:179], v12 offset:33792
    buffer_load_dwordx4 a[16:19], v1, s[20:23], s81 offen offset:0 sc1
    v_mfma_f32_32x32x16_bf16 v[64:79], v[188:191], v[200:203], v[64:79]
    ds_read_b64_tr_b16 v[180:181], v12 offset:49152
    v_mfma_f32_32x32x16_bf16 v[80:95], v[188:191], v[204:207], v[80:95]
    ds_read_b64_tr_b16 v[182:183], v12 offset:50176
    buffer_load_dwordx4 a[20:23], v1, s[20:23], s81 offen offset:1024 sc1
    v_mfma_f32_32x32x16_bf16 v[96:111], v[192:195], v[200:203], v[96:111]
    ds_read_b128 v[160:163], v8 offset:16384
    v_mfma_f32_32x32x16_bf16 v[112:127], v[192:195], v[204:207], v[112:127]
    ds_read_b128 v[164:167], v8 offset:20480
    buffer_load_dwordx4 a[24:27], v1, s[20:23], s81 offen offset:2048 sc1
    v_mfma_f32_32x32x16_bf16 v[128:143], v[196:199], v[200:203], v[128:143]
    ds_read_b128 v[168:171], v8 offset:24576
    v_mfma_f32_32x32x16_bf16 v[144:159], v[196:199], v[204:207], v[144:159]
    ds_read_b128 v[172:175], v8 offset:28672
    buffer_load_dwordx4 a[28:31], v1, s[20:23], s81 offen offset:3072 sc1
    s_add_u32 s81, s81, 4096
    s_cmp_ge_u32 s81, s47
    s_cselect_b32 s81, s46, s81
    s_waitcnt lgkmcnt(0)
    v_mfma_f32_32x32x16_bf16 v[32:47], v[160:163], v[176:179], v[32:47]
    ds_read_b64_tr_b16 v[200:201], v12 offset:36864
    v_mfma_f32_32x32x16_bf16 v[48:63], v[160:163], v[180:183], v[48:63]
    ds_read_b64_tr_b16 v[202:203], v12 offset:37888
    buffer_load_dwordx4 a[32:35], v1, s[20:23], s81 offen offset:0 sc1
    v_mfma_f32_32x32x16_bf16 v[64:79], v[164:167], v[176:179], v[64:79]
    ds_read_b64_tr_b16 v[204:205], v12 offset:53248
    v_mfma_f32_32x32x16_bf16 v[80:95], v[164:167], v[180:183], v[80:95]
    ds_read_b64_tr_b16 v[206:207], v12 offset:54272
    buffer_load_dwordx4 a[36:39], v1, s[20:23], s81 offen offset:1024 sc1
    v_mfma_f32_32x32x16_bf16 v[96:111], v[168:171], v[176:179], v[96:111]
    ds_read_b128 v[184:187], v9 offset:16384
    v_mfma_f32_32x32x16_bf16 v[112:127], v[168:171], v[180:183], v[112:127]
    ds_read_b128 v[188:191], v9 offset:20480
    buffer_load_dwordx4 a[40:43], v1, s[20:23], s81 offen offset:2048 sc1
    v_mfma_f32_32x32x16_bf16 v[128:143], v[172:175], v[176:179], v[128:143]
    ds_read_b128 v[192:195], v9 offset:24576
    v_mfma_f32_32x32x16_bf16 v[144:159], v[172:175], v[180:183], v[144:159]
    ds_read_b128 v[196:199], v9 offset:28672
    buffer_load_dwordx4 a[44:47], v1, s[20:23], s81 offen offset:3072 sc1
    s_add_u32 s81, s81, 4096
    s_cmp_ge_u32 s81, s47
    s_cselect_b32 s81, s46, s81
    s_waitcnt lgkmcnt(0)
    v_mfma_f32_32x32x16_bf16 v[32:47], v[184:187], v[200:203], v[32:47]
    ds_read_b64_tr_b16 v[176:177], v12 offset:40960
    v_mfma_f32_32x32x16_bf16 v[48:63], v[184:187], v[204:207], v[48:63]
    ds_read_b64_tr_b16 v[178:179], v12 offset:41984
    buffer_load_dwordx4 a[48:51], v1, s[20:23], s81 offen offset:0 sc1
    v_mfma_f32_32x32x16_bf16 v[64:79], v[188:191], v[200:203], v[64:79]
    ds_read_b64_tr_b16 v[180:181], v12 offset:57344
    v_mfma_f32_32x32x16_bf16 v[80:95], v[188:191], v[204:207], v[80:95]
    ds_read_b64_tr_b16 v[182:183], v12 offset:58368
    buffer_load_dwordx4 a[52:55], v1, s[20:23], s81 offen offset:1024 sc1
    v_mfma_f32_32x32x16_bf16 v[96:111], v[192:195], v[200:203], v[96:111]
    ds_read_b128 v[160:163], v10 offset:16384
    v_mfma_f32_32x32x16_bf16 v[112:127], v[192:195], v[204:207], v[112:127]
    ds_read_b128 v[164:167], v10 offset:20480
    buffer_load_dwordx4 a[56:59], v1, s[20:23], s81 offen offset:2048 sc1
    v_mfma_f32_32x32x16_bf16 v[128:143], v[196:199], v[200:203], v[128:143]
    ds_read_b128 v[168:171], v10 offset:24576
    v_mfma_f32_32x32x16_bf16 v[144:159], v[196:199], v[204:207], v[144:159]
    ds_read_b128 v[172:175], v10 offset:28672
    buffer_load_dwordx4 a[60:63], v1, s[20:23], s81 offen offset:3072 sc1
    s_add_u32 s81, s81, 4096
    s_cmp_ge_u32 s81, s47
    s_cselect_b32 s81, s46, s81
    s_waitcnt lgkmcnt(0)
    v_mfma_f32_32x32x16_bf16 v[32:47], v[160:163], v[176:179], v[32:47]
    ds_read_b64_tr_b16 v[200:201], v12 offset:45056
    v_mfma_f32_32x32x16_bf16 v[48:63], v[160:163], v[180:183], v[48:63]
    ds_read_b64_tr_b16 v[202:203], v12 offset:46080
    buffer_load_dwordx4 a[64:67], v1, s[20:23], s81 offen offset:0 sc1
    v_mfma_f32_32x32x16_bf16 v[64:79], v[164:167], v[176:179], v[64:79]
    ds_read_b64_tr_b16 v[204:205], v12 offset:61440
    v_mfma_f32_32x32x16_bf16 v[80:95], v[164:167], v[180:183], v[80:95]
    ds_read_b64_tr_b16 v[206:207], v12 offset:62464
    buffer_load_dwordx4 a[68:71], v1, s[20:23], s81 offen offset:1024 sc1
    v_mfma_f32_32x32x16_bf16 v[96:111], v[168:171], v[176:179], v[96:111]
    ds_read_b128 v[184:187], v11 offset:16384
    v_mfma_f32_32x32x16_bf16 v[112:127], v[168:171], v[180:183], v[112:127]
    ds_read_b128 v[188:191], v11 offset:20480
    buffer_load_dwordx4 a[72:75], v1, s[20:23], s81 offen offset:2048 sc1
    v_mfma_f32_32x32x16_bf16 v[128:143], v[172:175], v[176:179], v[128:143]
    ds_read_b128 v[192:195], v11 offset:24576
    v_mfma_f32_32x32x16_bf16 v[144:159], v[172:175], v[180:183], v[144:159]
    ds_read_b128 v[196:199], v11 offset:28672
    buffer_load_dwordx4 a[76:79], v1, s[20:23], s81 offen offset:3072 sc1
    s_add_u32 s81, s81, 4096
    s_cmp_ge_u32 s81, s47
    s_cselect_b32 s81, s46, s81
    s_waitcnt lgkmcnt(0)
    v_mfma_f32_32x32x16_bf16 v[32:47], v[184:187], v[200:203], v[32:47]
    v_mfma_f32_32x32x16_bf16 v[48:63], v[184:187], v[204:207], v[48:63]
    buffer_load_dwordx4 a[80:83], v1, s[20:23], s81 offen offset:0 sc1
    v_mfma_f32_32x32x16_bf16 v[64:79], v[188:191], v[200:203], v[64:79]
    v_mfma_f32_32x32x16_bf16 v[80:95], v[188:191], v[204:207], v[80:95]
    buffer_load_dwordx4 a[84:87], v1, s[20:23], s81 offen offset:1024 sc1
    v_mfma_f32_32x32x16_bf16 v[96:111], v[192:195], v[200:203], v[96:111]
    v_mfma_f32_32x32x16_bf16 v[112:127], v[192:195], v[204:207], v[112:127]
    buffer_load_dwordx4 a[88:91], v1, s[20:23], s81 offen offset:2048 sc1
    v_mfma_f32_32x32x16_bf16 v[128:143], v[196:199], v[200:203], v[128:143]
    v_mfma_f32_32x32x16_bf16 v[144:159], v[196:199], v[204:207], v[144:159]
    buffer_load_dwordx4 a[92:95], v1, s[20:23], s81 offen offset:3072 sc1
    s_add_u32 s81, s81, 4096
    s_cmp_ge_u32 s81, s47
    s_cselect_b32 s81, s46, s81
    buffer_load_dwordx4 a[96:99], v1, s[20:23], s81 offen offset:0 sc1
    buffer_load_dwordx4 a[100:103], v1, s[20:23], s81 offen offset:1024 sc1
    buffer_load_dwordx4 a[104:107], v1, s[20:23], s81 offen offset:2048 sc1
    buffer_load_dwordx4 a[108:111], v1, s[20:23], s81 offen offset:3072 sc1
    s_add_u32 s81, s81, 4096
    s_cmp_ge_u32 s81, s47
    s_cselect_b32 s81, s46, s81
    buffer_load_dwordx4 a[112:115], v1, s[20:23], s81 offen offset:0 sc1
    buffer_load_dwordx4 a[116:119], v1, s[20:23], s81 offen offset:1024 sc1
    buffer_load_dwordx4 a[120:123], v1, s[20:23], s81 offen offset:2048 sc1
    buffer_load_dwordx4 a[124:127], v1, s[20:23], s81 offen offset:3072 sc1
    s_add_u32 s81, s81, 4096
    s_cmp_ge_u32 s81, s47
    s_cselect_b32 s81, s46, s81
    s_cmp_eq_u32 s7, 14
    s_cselect_b32 s64, 1.0, -1.0
    s_mul_i32 s36, s3, 33
    s_lshl_b32 s36, s36, 11
    s_sub_u32 s38, s7, 14
    s_lshl_b32 s38, s38, 10
    s_add_u32 s36, s36, s38
    s_add_u32 s36, s36, 9175040
    s_lshl_b32 s38, s7, 2
    s_add_u32 s38, s38, s3
    s_cmp_eq_u32 s38, 60
    s_cselect_b32 s66, -2, -1
    s_mov_b32 s67, s66
    v_mov_b32 v25, 0
    v_mov_b32 v26, 0
    v_mov_b32 v27, 0
    v_cmp_gt_u32 vcc, 32, v0
    s_nop 7
    s_cmp_eq_u32 s6, 0
    s_cbranch_scc0 DGEN0
    v_fma_f32 v24, v64, s64, v96
    v_cvt_pk_bf16_f32 v24, v24, 0
    v_cndmask_b32 v24, 0, v24, vcc
    v_cndmask_b32 v64, v64, v25, vcc
    v_cndmask_b32 v96, v96, v25, vcc
    s_add_u32 s38, s36, 65536
    s_add_u32 s39, s36, 606208
    s_mov_b64 exec, s[66:67]
    buffer_store_dwordx4 v[24:27], v1, s[20:23], s38 offen sc1
    buffer_store_dwordx4 v[24:27], v1, s[20:23], s39 offen sc1
    s_mov_b64 exec, -1
DGEN0:
    s_lshl_b32 s38, s6, 12
    s_add_u32 s38, s36, s38
    s_add_u32 s39, s38, 540672
    v_fma_f32 v32, v64, s64, v32
    v_fma_f32 v128, v96, s64, v128
    v_fma_f32 v33, v65, s64, v33
    v_fma_f32 v129, v97, s64, v129
    v_fma_f32 v34, v66, s64, v34
    v_fma_f32 v130, v98, s64, v130
    v_fma_f32 v35, v67, s64, v35
    v_fma_f32 v131, v99, s64, v131
    v_fma_f32 v36, v68, s64, v36
    v_fma_f32 v132, v100, s64, v132
    v_fma_f32 v37, v69, s64, v37
    v_fma_f32 v133, v101, s64, v133
    v_fma_f32 v38, v70, s64, v38
    v_fma_f32 v134, v102, s64, v134
    v_fma_f32 v39, v71, s64, v39
    v_fma_f32 v135, v103, s64, v135
    v_fma_f32 v40, v72, s64, v40
    v_fma_f32 v136, v104, s64, v136
    v_fma_f32 v41, v73, s64, v41
    v_fma_f32 v137, v105, s64, v137
    v_fma_f32 v42, v74, s64, v42
    v_fma_f32 v138, v106, s64, v138
    v_fma_f32 v43, v75, s64, v43
    v_fma_f32 v139, v107, s64, v139
    v_fma_f32 v44, v76, s64, v44
    v_fma_f32 v140, v108, s64, v140
    v_fma_f32 v45, v77, s64, v45
    v_fma_f32 v141, v109, s64, v141
    v_fma_f32 v46, v78, s64, v46
    v_fma_f32 v142, v110, s64, v142
    v_fma_f32 v47, v79, s64, v47
    v_fma_f32 v143, v111, s64, v143
    v_add_f32 v64, v32, v128
    v_sub_f32 v96, v32, v128
    v_add_f32 v65, v33, v129
    v_sub_f32 v97, v33, v129
    v_add_f32 v66, v34, v130
    v_sub_f32 v98, v34, v130
    v_add_f32 v67, v35, v131
    v_sub_f32 v99, v35, v131
    v_add_f32 v68, v36, v132
    v_sub_f32 v100, v36, v132
    v_add_f32 v69, v37, v133
    v_sub_f32 v101, v37, v133
    v_add_f32 v70, v38, v134
    v_sub_f32 v102, v38, v134
    v_add_f32 v71, v39, v135
    v_sub_f32 v103, v39, v135
    v_add_f32 v72, v40, v136
    v_sub_f32 v104, v40, v136
    v_add_f32 v73, v41, v137
    v_sub_f32 v105, v41, v137
    v_add_f32 v74, v42, v138
    v_sub_f32 v106, v42, v138
    v_add_f32 v75, v43, v139
    v_sub_f32 v107, v43, v139
    v_add_f32 v76, v44, v140
    v_sub_f32 v108, v44, v140
    v_add_f32 v77, v45, v141
    v_sub_f32 v109, v45, v141
    v_add_f32 v78, v46, v142
    v_sub_f32 v110, v46, v142
    v_add_f32 v79, v47, v143
    v_sub_f32 v111, v47, v143
    v_cvt_pk_bf16_f32 v32, v64, v65
    v_cvt_pk_bf16_f32 v33, v66, v67
    v_cvt_pk_bf16_f32 v34, v68, v69
    v_cvt_pk_bf16_f32 v35, v70, v71
    v_cvt_pk_bf16_f32 v36, v72, v73
    v_cvt_pk_bf16_f32 v37, v74, v75
    v_cvt_pk_bf16_f32 v38, v76, v77
    v_cvt_pk_bf16_f32 v39, v78, v79
    v_cvt_pk_bf16_f32 v40, v96, v97
    v_cvt_pk_bf16_f32 v41, v98, v99
    v_cvt_pk_bf16_f32 v42, v100, v101
    v_cvt_pk_bf16_f32 v43, v102, v103
    v_cvt_pk_bf16_f32 v44, v104, v105
    v_cvt_pk_bf16_f32 v45, v106, v107
    v_cvt_pk_bf16_f32 v46, v108, v109
    v_cvt_pk_bf16_f32 v47, v110, v111
    s_mov_b64 exec, s[66:67]
    buffer_store_dwordx4 v[32:35], v1, s[20:23], s38 offen offset:0 sc1
    buffer_store_dwordx4 v[36:39], v1, s[20:23], s38 offen offset:2048 sc1
    buffer_store_dwordx4 v[40:43], v1, s[20:23], s39 offen offset:0 sc1
    buffer_store_dwordx4 v[44:47], v1, s[20:23], s39 offen offset:2048 sc1
    s_mov_b64 exec, -1
    s_add_u32 s36, s36, 270336
    s_cmp_eq_u32 s6, 0
    s_cbranch_scc0 DGEN1
    v_fma_f32 v24, v80, s64, v112
    v_cvt_pk_bf16_f32 v24, v24, 0
    v_cndmask_b32 v24, 0, v24, vcc
    v_cndmask_b32 v80, v80, v25, vcc
    v_cndmask_b32 v112, v112, v25, vcc
    s_add_u32 s38, s36, 65536
    s_add_u32 s39, s36, 606208
    buffer_store_dwordx4 v[24:27], v1, s[20:23], s38 offen sc1
    buffer_store_dwordx4 v[24:27], v1, s[20:23], s39 offen sc1
    s_mov_b64 exec, -1
DGEN1:
    s_lshl_b32 s38, s6, 12
    s_add_u32 s38, s36, s38
    s_add_u32 s39, s38, 540672
    v_fma_f32 v48, v80, s64, v48
    v_fma_f32 v144, v112, s64, v144
    v_fma_f32 v49, v81, s64, v49
    v_fma_f32 v145, v113, s64, v145
    v_fma_f32 v50, v82, s64, v50
    v_fma_f32 v146, v114, s64, v146
    v_fma_f32 v51, v83, s64, v51
    v_fma_f32 v147, v115, s64, v147
    v_fma_f32 v52, v84, s64, v52
    v_fma_f32 v148, v116, s64, v148
    v_fma_f32 v53, v85, s64, v53
    v_fma_f32 v149, v117, s64, v149
    v_fma_f32 v54, v86, s64, v54
    v_fma_f32 v150, v118, s64, v150
    v_fma_f32 v55, v87, s64, v55
    v_fma_f32 v151, v119, s64, v151
    v_fma_f32 v56, v88, s64, v56
    v_fma_f32 v152, v120, s64, v152
    v_fma_f32 v57, v89, s64, v57
    v_fma_f32 v153, v121, s64, v153
    v_fma_f32 v58, v90, s64, v58
    v_fma_f32 v154, v122, s64, v154
    v_fma_f32 v59, v91, s64, v59
    v_fma_f32 v155, v123, s64, v155
    v_fma_f32 v60, v92, s64, v60
    v_fma_f32 v156, v124, s64, v156
    v_fma_f32 v61, v93, s64, v61
    v_fma_f32 v157, v125, s64, v157
    v_fma_f32 v62, v94, s64, v62
    v_fma_f32 v158, v126, s64, v158
    v_fma_f32 v63, v95, s64, v63
    v_fma_f32 v159, v127, s64, v159
    v_add_f32 v80, v48, v144
    v_sub_f32 v112, v48, v144
    v_add_f32 v81, v49, v145
    v_sub_f32 v113, v49, v145
    v_add_f32 v82, v50, v146
    v_sub_f32 v114, v50, v146
    v_add_f32 v83, v51, v147
    v_sub_f32 v115, v51, v147
    v_add_f32 v84, v52, v148
    v_sub_f32 v116, v52, v148
    v_add_f32 v85, v53, v149
    v_sub_f32 v117, v53, v149
    v_add_f32 v86, v54, v150
    v_sub_f32 v118, v54, v150
    v_add_f32 v87, v55, v151
    v_sub_f32 v119, v55, v151
    v_add_f32 v88, v56, v152
    v_sub_f32 v120, v56, v152
    v_add_f32 v89, v57, v153
    v_sub_f32 v121, v57, v153
    v_add_f32 v90, v58, v154
    v_sub_f32 v122, v58, v154
    v_add_f32 v91, v59, v155
    v_sub_f32 v123, v59, v155
    v_add_f32 v92, v60, v156
    v_sub_f32 v124, v60, v156
    v_add_f32 v93, v61, v157
    v_sub_f32 v125, v61, v157
    v_add_f32 v94, v62, v158
    v_sub_f32 v126, v62, v158
    v_add_f32 v95, v63, v159
    v_sub_f32 v127, v63, v159
    v_cvt_pk_bf16_f32 v48, v80, v81
    v_cvt_pk_bf16_f32 v49, v82, v83
    v_cvt_pk_bf16_f32 v50, v84, v85
    v_cvt_pk_bf16_f32 v51, v86, v87
    v_cvt_pk_bf16_f32 v52, v88, v89
    v_cvt_pk_bf16_f32 v53, v90, v91
    v_cvt_pk_bf16_f32 v54, v92, v93
    v_cvt_pk_bf16_f32 v55, v94, v95
    v_cvt_pk_bf16_f32 v56, v112, v113
    v_cvt_pk_bf16_f32 v57, v114, v115
    v_cvt_pk_bf16_f32 v58, v116, v117
    v_cvt_pk_bf16_f32 v59, v118, v119
    v_cvt_pk_bf16_f32 v60, v120, v121
    v_cvt_pk_bf16_f32 v61, v122, v123
    v_cvt_pk_bf16_f32 v62, v124, v125
    v_cvt_pk_bf16_f32 v63, v126, v127
    buffer_store_dwordx4 v[48:51], v1, s[20:23], s38 offen offset:0 sc1
    buffer_store_dwordx4 v[52:55], v1, s[20:23], s38 offen offset:2048 sc1
    buffer_store_dwordx4 v[56:59], v1, s[20:23], s39 offen offset:0 sc1
    buffer_store_dwordx4 v[60:63], v1, s[20:23], s39 offen offset:2048 sc1
    s_mov_b64 exec, -1
    s_add_u32 s36, s36, 270336
    s_branch P1_DONE
CODE_END:
.section .rodata,"a"
.p2align 6
.amdhsa_kernel gated_mix__spectral_fnet__swiglu_ffn__prompt_kernel
  .amdhsa_next_free_vgpr 512
  .amdhsa_next_free_sgpr 102
  .amdhsa_accum_offset 256
  .amdhsa_group_segment_fixed_size 0
  .amdhsa_kernarg_size 104
  .amdhsa_user_sgpr_count 2
  .amdhsa_user_sgpr_kernarg_segment_ptr 1
  .amdhsa_system_sgpr_workgroup_id_x 1
.end_amdhsa_kernel
```
